```python
import torch

def _softmax(x, axis=-1):
    return torch.softmax(x, dim=axis)
def _gelu(x):
    return torch.nn.functional.gelu(x, approximate="tanh")
def _silu(x):
    return torch.nn.functional.silu(x)
def _sigmoid(x):
    return torch.sigmoid(x)
def _layernorm(x, axis=-1, eps=1e-5):
    m = x.mean(dim=axis, keepdim=True)
    v = x.var(dim=axis, keepdim=True, unbiased=False)
    return (x - m) / torch.sqrt(v + eps)
def _scatter_add(tgt, idx, src, axis=0):
    return tgt.clone().index_add_(axis, idx, src)
def _segment_sum(src, seg, n):
    out = torch.zeros((n,) + src.shape[1:], dtype=src.dtype)
    return out.index_add_(0, seg, src)
def _pad(x, pw):
    flat = tuple(v for pair in reversed(pw) for v in pair)
    return torch.nn.functional.pad(x, flat)

kernel_name = 'sequential_preLN__mha_block_cached__geglu_ffn__decode'

def setup_inputs():

    _w = (lambda a: (lambda t: t.to(torch.bfloat16) if t.is_floating_point() else t)(torch.as_tensor(a)))
    def _A_setup():
        B, Sq, D = 2, 1, 448
        H, Sk, Dh = 16, 8192, 256
        return {
            "x": _w((lambda *s: torch.randn(*s, dtype=torch.bfloat16) * 0.05)(B, Sq, D)),
            "k_cache": _w((lambda *s: torch.randn(*s, dtype=torch.bfloat16) * 3.2)(B, H, Sk, Dh)),
            "v_cache": _w((lambda *s: torch.randn(*s, dtype=torch.bfloat16) * 0.4)(B, H, Sk, Dh)),
            "wq": _w((lambda *s: torch.randn(*s, dtype=torch.bfloat16) * 3.2)(D, H * Dh) * (D ** -0.5)),
            "wo": _w((lambda *s: torch.randn(*s, dtype=torch.bfloat16) * 0.4)(H * Dh, D) * ((H * Dh) ** -0.5)),
        }
    _A_in = _A_setup()

    def _B_setup():
        B, S, D, F = 2, 1, 448, 1792
        return {
            "x": _w((lambda *s: torch.randn(*s, dtype=torch.bfloat16) * 0.05)(B, S, D)),
            "w_gate": _w((lambda *s: torch.randn(*s, dtype=torch.bfloat16) * 0.05)(D, F)),
            "w_up": _w((lambda *s: torch.randn(*s, dtype=torch.bfloat16) * 0.05)(D, F)),
            "w_down": _w((lambda *s: torch.randn(*s, dtype=torch.bfloat16) * 0.05)(F, D)),
        }
    _B_in = _B_setup()

    return {
        "A_x": _A_in["x"],
        "A_k_cache": _A_in["k_cache"],
        "A_v_cache": _A_in["v_cache"],
        "A_wq": _A_in["wq"],
        "A_wo": _A_in["wo"],
        "B_x": _B_in["x"],
        "B_w_gate": _B_in["w_gate"],
        "B_w_up": _B_in["w_up"],
        "B_w_down": _B_in["w_down"],
    }

def reference(A_x, A_k_cache, A_v_cache, A_wq, A_wo, B_x, B_w_gate, B_w_up, B_w_down):
    def _A_ref(x, k_cache, v_cache, wq, wo):
        B, Sq, D = x.shape
        H, Dh = 16, 256
        q = (lambda x, *d: x.permute(*d))((x @ wq).reshape(B, Sq, H, Dh), 0, 2, 1, 3)
        scores = torch.einsum("bhqd,bhkd->bhqk", q, k_cache) * (Dh ** -0.5)
        p = _softmax(scores, axis=-1)
        o = torch.einsum("bhqk,bhkd->bhqd", p, v_cache)
        return (lambda x, *d: x.permute(*d))(o, 0, 2, 1, 3).reshape(B, Sq, H * Dh) @ wo

    def _B_ref(x, w_gate, w_up, w_down):
        return (_gelu(x @ w_gate) * (x @ w_up)) @ w_down

    x = A_x
    h = x + _A_ref(_layernorm(x, axis=-1), A_k_cache, A_v_cache, A_wq, A_wo)
    h2 = h + _B_ref(_layernorm(h, axis=-1), B_w_gate, B_w_up, B_w_down)
    return h2
```

```asm
; @launch grid=(256,1,1) block=(384,1,1) lds=159744
.amdgcn_target "amdgcn-amd-amdhsa--gfx950"
.text
.globl sequential_preLN__mha_block_cached__geglu_ffn__decode_kernel
.p2align 8
.type sequential_preLN__mha_block_cached__geglu_ffn__decode_kernel,@function
sequential_preLN__mha_block_cached__geglu_ffn__decode_kernel:
    s_cmp_ge_u32 s2, 256
    s_cbranch_scc1 L_end
    s_load_dwordx16 s[32:47], s[0:1], 0
    s_load_dwordx8 s[48:55], s[0:1], 64
    v_lshrrev_b32 v1, 6, v0
    s_nop 0
    v_readfirstlane_b32 s3, v1
    v_and_b32 v1, 63, v0
    s_lshr_b32 s31, s2, 3
    s_and_b32 s24, s2, 7
    s_mul_i32 s58, s31, 37
    s_lshr_b32 s58, s58, 8
    s_mul_i32 s25, s58, 7
    s_sub_u32 s59, s31, s25
    s_cmp_gt_u32 s24, 7
    s_cselect_b32 s25, 6, 7
    s_add_u32 s28, s24, s25
    s_sub_u32 s28, s28, s59
    s_cmp_ge_u32 s28, 7
    s_cselect_b32 s25, 7, 0
    s_sub_u32 s28, s28, s25
    s_cmp_eq_u32 s24, 7
    s_cselect_b32 s28, 7, s28
    s_cmp_lt_u32 s28, 2
    s_cselect_b32 s57, 3, 0
    s_cselect_b32 s84, 14, 15
    s_cmp_lt_u32 s31, 28
    s_cselect_b32 s25, 1, 0
    s_cmp_eq_u32 s28, 7
    s_cselect_b32 s57, s25, s57
    s_cselect_b32 s84, 9, s84
    s_mov_b32 s26, 0x56381c00
    s_mov_b32 s27, 0xceb09274
    s_lshl_b32 s25, s28, 3
    s_lshr_b64 s[26:27], s[26:27], s25
    s_and_b32 s26, s26, 0xff
    s_lshl_b32 s86, s26, 14
    s_lshl_b32 s85, s31, 22
    s_lshl_b32 s23, s3, 10
    v_lshl_add_u32 v2, v1, 4, s23
    s_mov_b32 s22, s86
    s_mov_b32 s6, 0x400000
    s_mov_b32 s7, 0x20000
    s_mov_b32 s10, 0x88000
    s_mov_b32 s11, 0x20000
    s_mov_b32 s15, 0x20000
    s_mov_b32 s19, 0x20000
    s_waitcnt lgkmcnt(0)
    s_add_u32 s4, s34, s85
    s_addc_u32 s5, s35, 0
    s_load_dword s56, s[54:55], 0
    s_mov_b32 s8, s54
    s_mov_b32 s9, s55
    s_mov_b32 s89, 0
    s_cmp_ge_u32 s3, 4
    s_cbranch_scc1 L_helper
    s_cmp_lg_u32 s57, 0
    s_cbranch_scc1 L_special
    buffer_load_dwordx4 v[64:67], v2, s[4:7], s22 offen nt
    s_addk_i32 s22, 0x1000
    buffer_load_dwordx4 v[68:71], v2, s[4:7], s22 offen nt
    s_addk_i32 s22, 0x1000
    buffer_load_dwordx4 v[72:75], v2, s[4:7], s22 offen nt
    s_addk_i32 s22, 0x1000
    buffer_load_dwordx4 v[76:79], v2, s[4:7], s22 offen nt
    s_addk_i32 s22, 0x1000
    buffer_load_dwordx4 v[80:83], v2, s[4:7], s22 offen nt
    s_addk_i32 s22, 0x1000
    buffer_load_dwordx4 v[84:87], v2, s[4:7], s22 offen nt
    s_addk_i32 s22, 0x1000
    s_branch L_qback
L_special:
    s_cmp_eq_u32 s57, 1
    s_cbranch_scc1 L_service
    s_lshl_b32 s29, s31, 1
    s_add_u32 s29, s29, s28
    s_mov_b32 s12, s32
    s_mov_b32 s13, s33
    s_mov_b32 s14, 1792
    v_mov_b32 v3, 0x10000
    v_cmp_gt_u32 vcc, 56, v0
    s_nop 1
    v_cndmask_b32 v3, v3, v2, vcc
    buffer_load_dwordx4 v[8:11], v3, s[12:15], 0 offen
    buffer_load_dwordx4 v[12:15], v3, s[12:15], 0 offen offset:896
    s_cmp_lg_u32 s3, 1
    s_cbranch_scc1 L_q1
    v_mov_b32 v16, -1
    v_mov_b32 v17, -1
    v_mov_b32 v18, -1
    v_mov_b32 v19, -1
    s_mul_i32 s24, s29, 2560
    s_add_u32 s24, s24, 64512
    buffer_store_dwordx4 v[16:19], v2, s[8:11], s24 offen offset:0 sc1
    buffer_store_dwordx4 v[16:19], v2, s[8:11], s24 offen offset:1024 sc1
    s_mov_b32 exec_hi, 0
    buffer_store_dwordx4 v[16:19], v2, s[8:11], s24 offen offset:2048 sc1
    s_mov_b64 exec, -1
L_q1:
    s_cmp_lg_u32 s3, 2
    s_cbranch_scc1 L_q2
    s_bitcmp1_b32 s29, 1
    s_cbranch_scc1 L_q2
    s_and_b32 s24, s29, 1
    s_lshl_b32 s24, s24, 4
    s_lshr_b32 s25, s29, 2
    s_add_u32 s24, s24, s25
    s_mul_i32 s24, s24, 4352
    s_add_u32 s24, s24, 393216
    v_mov_b32 v16, 0
    s_mov_b64 exec, 1
    buffer_store_dword v16, v16, s[8:11], s24 offen sc1
    s_mov_b64 exec, -1
L_q2:
    s_lshl_b32 s24, s29, 7
    s_add_u32 s16, s38, s24
    s_addc_u32 s17, s39, 0
    s_sub_u32 s18, 3670016, s24
    s_and_b32 s24, s3, 1
    s_lshl_b32 s24, s24, 2
    v_lshrrev_b32 v4, 3, v1
    v_mul_u32_u24 v4, 8192, v4
    v_and_b32 v5, 7, v1
    v_bfe_u32 v6, v1, 4, 1
    v_lshl_or_b32 v6, v6, 1, s24
    v_xor_b32 v5, v5, v6
    v_lshl_add_u32 v4, v5, 4, v4
    s_lshl_b32 s24, s3, 16
    s_add_u32 m0, s23, 16384
    s_nop 0
    buffer_load_dwordx4 v4, s[16:19], s24 offen nt lds
    s_add_u32 m0, m0, 4096
    s_add_u32 s24, s24, 0x40000
    buffer_load_dwordx4 v4, s[16:19], s24 offen nt lds
    s_add_u32 m0, m0, 4096
    s_add_u32 s24, s24, 0x40000
    buffer_load_dwordx4 v4, s[16:19], s24 offen nt lds
    s_add_u32 m0, m0, 4096
    s_add_u32 s24, s24, 0x40000
    buffer_load_dwordx4 v4, s[16:19], s24 offen nt lds
    s_add_u32 m0, m0, 4096
    s_add_u32 s24, s24, 0x40000
    buffer_load_dwordx4 v4, s[16:19], s24 offen nt lds
    s_add_u32 m0, m0, 4096
    s_add_u32 s24, s24, 0x40000
    buffer_load_dwordx4 v4, s[16:19], s24 offen nt lds
    s_add_u32 m0, m0, 4096
    s_add_u32 s24, s24, 0x40000
    buffer_load_dwordx4 v4, s[16:19], s24 offen nt lds
    s_add_u32 m0, m0, 4096
    s_add_u32 s24, s24, 0x40000
    buffer_load_dwordx4 v4, s[16:19], s24 offen nt lds
    s_add_u32 m0, m0, 4096
    s_add_u32 s24, s24, 0x40000
    buffer_load_dwordx4 v4, s[16:19], s24 offen nt lds
    s_add_u32 m0, m0, 4096
    s_add_u32 s24, s24, 0x40000
    buffer_load_dwordx4 v4, s[16:19], s24 offen nt lds
    s_add_u32 m0, m0, 4096
    s_add_u32 s24, s24, 0x40000
    buffer_load_dwordx4 v4, s[16:19], s24 offen nt lds
    s_add_u32 m0, m0, 4096
    s_add_u32 s24, s24, 0x40000
    buffer_load_dwordx4 v4, s[16:19], s24 offen nt lds
    s_add_u32 m0, m0, 4096
    s_add_u32 s24, s24, 0x40000
    buffer_load_dwordx4 v4, s[16:19], s24 offen nt lds
    s_add_u32 m0, m0, 4096
    s_add_u32 s24, s24, 0x40000
    buffer_load_dwordx4 v4, s[16:19], s24 offen nt lds
    s_add_u32 m0, m0, 4096
    s_add_u32 s24, s24, 0x40000
    buffer_load_dwordx4 v[64:67], v2, s[4:7], s22 offen nt
    s_addk_i32 s22, 0x1000
    buffer_load_dwordx4 v[68:71], v2, s[4:7], s22 offen nt
    s_addk_i32 s22, 0x1000
    buffer_load_dwordx4 v[72:75], v2, s[4:7], s22 offen nt
    s_addk_i32 s22, 0x1000
    buffer_load_dwordx4 v[76:79], v2, s[4:7], s22 offen nt
    s_addk_i32 s22, 0x1000
    buffer_load_dwordx4 v[80:83], v2, s[4:7], s22 offen nt
    s_addk_i32 s22, 0x1000
    buffer_load_dwordx4 v[84:87], v2, s[4:7], s22 offen nt
    s_addk_i32 s22, 0x1000
    s_waitcnt vmcnt(20)
    s_cmp_lg_u32 s3, 0
    s_cbranch_scc1 L_qnoln
    v_lshlrev_b32 v32, 16, v8
    v_and_b32 v33, 0xffff0000, v8
    v_lshlrev_b32 v34, 16, v9
    v_and_b32 v35, 0xffff0000, v9
    v_lshlrev_b32 v36, 16, v10
    v_and_b32 v37, 0xffff0000, v10
    v_lshlrev_b32 v38, 16, v11
    v_and_b32 v39, 0xffff0000, v11
    v_lshlrev_b32 v40, 16, v12
    v_and_b32 v41, 0xffff0000, v12
    v_lshlrev_b32 v42, 16, v13
    v_and_b32 v43, 0xffff0000, v13
    v_lshlrev_b32 v44, 16, v14
    v_and_b32 v45, 0xffff0000, v14
    v_lshlrev_b32 v46, 16, v15
    v_and_b32 v47, 0xffff0000, v15
    v_add_f32 v20, v32, v33
    v_add_f32 v20, v20, v34
    v_add_f32 v20, v20, v35
    v_add_f32 v20, v20, v36
    v_add_f32 v20, v20, v37
    v_add_f32 v20, v20, v38
    v_add_f32 v20, v20, v39
    v_add_f32 v21, v40, v41
    v_add_f32 v21, v21, v42
    v_add_f32 v21, v21, v43
    v_add_f32 v21, v21, v44
    v_add_f32 v21, v21, v45
    v_add_f32 v21, v21, v46
    v_add_f32 v21, v21, v47
    v_add_f32_dpp v20, v20, v20 quad_perm:[1,0,3,2] row_mask:0xf bank_mask:0xf
    s_nop 0
    v_add_f32_dpp v21, v21, v21 quad_perm:[1,0,3,2] row_mask:0xf bank_mask:0xf
    v_add_f32_dpp v20, v20, v20 quad_perm:[2,3,0,1] row_mask:0xf bank_mask:0xf
    s_nop 0
    v_add_f32_dpp v21, v21, v21 quad_perm:[2,3,0,1] row_mask:0xf bank_mask:0xf
    v_add_f32_dpp v20, v20, v20 row_half_mirror row_mask:0xf bank_mask:0xf
    s_nop 0
    v_add_f32_dpp v21, v21, v21 row_half_mirror row_mask:0xf bank_mask:0xf
    v_add_f32_dpp v20, v20, v20 row_mirror row_mask:0xf bank_mask:0xf
    s_nop 0
    v_add_f32_dpp v21, v21, v21 row_mirror row_mask:0xf bank_mask:0xf
    v_mov_b32 v22, v20
    v_mov_b32 v23, v21
    s_nop 0
    v_permlane16_swap_b32 v20, v22
    v_permlane16_swap_b32 v21, v23
    v_add_f32 v20, v20, v22
    v_add_f32 v21, v21, v23
    v_mov_b32 v22, v20
    v_mov_b32 v23, v21
    s_nop 0
    v_permlane32_swap_b32 v20, v22
    v_permlane32_swap_b32 v21, v23
    v_add_f32 v20, v20, v22
    v_add_f32 v21, v21, v23
    s_mov_b32 s27, 0x3b124925
    v_mul_f32 v20, s27, v20
    v_mul_f32 v21, s27, v21
    v_mov_b32 v24, 0
    v_mov_b32 v25, 0
    s_mov_b32 exec_hi, 0x00ffffff
    v_sub_f32 v32, v32, v20
    v_sub_f32 v33, v33, v20
    v_sub_f32 v34, v34, v20
    v_sub_f32 v35, v35, v20
    v_sub_f32 v36, v36, v20
    v_sub_f32 v37, v37, v20
    v_sub_f32 v38, v38, v20
    v_sub_f32 v39, v39, v20
    v_fmac_f32 v24, v32, v32
    v_fmac_f32 v24, v33, v33
    v_fmac_f32 v24, v34, v34
    v_fmac_f32 v24, v35, v35
    v_fmac_f32 v24, v36, v36
    v_fmac_f32 v24, v37, v37
    v_fmac_f32 v24, v38, v38
    v_fmac_f32 v24, v39, v39
    v_sub_f32 v40, v40, v21
    v_sub_f32 v41, v41, v21
    v_sub_f32 v42, v42, v21
    v_sub_f32 v43, v43, v21
    v_sub_f32 v44, v44, v21
    v_sub_f32 v45, v45, v21
    v_sub_f32 v46, v46, v21
    v_sub_f32 v47, v47, v21
    v_fmac_f32 v25, v40, v40
    v_fmac_f32 v25, v41, v41
    v_fmac_f32 v25, v42, v42
    v_fmac_f32 v25, v43, v43
    v_fmac_f32 v25, v44, v44
    v_fmac_f32 v25, v45, v45
    v_fmac_f32 v25, v46, v46
    v_fmac_f32 v25, v47, v47
    s_mov_b64 exec, -1
    v_add_f32_dpp v24, v24, v24 quad_perm:[1,0,3,2] row_mask:0xf bank_mask:0xf
    v_add_f32_dpp v25, v25, v25 quad_perm:[1,0,3,2] row_mask:0xf bank_mask:0xf
    s_nop 0
    v_add_f32_dpp v24, v24, v24 quad_perm:[2,3,0,1] row_mask:0xf bank_mask:0xf
    v_add_f32_dpp v25, v25, v25 quad_perm:[2,3,0,1] row_mask:0xf bank_mask:0xf
    s_nop 0
    v_add_f32_dpp v24, v24, v24 row_half_mirror row_mask:0xf bank_mask:0xf
    v_add_f32_dpp v25, v25, v25 row_half_mirror row_mask:0xf bank_mask:0xf
    s_nop 0
    v_add_f32_dpp v24, v24, v24 row_mirror row_mask:0xf bank_mask:0xf
    v_add_f32_dpp v25, v25, v25 row_mirror row_mask:0xf bank_mask:0xf
    v_mov_b32 v22, v24
    v_mov_b32 v23, v25
    s_nop 0
    v_permlane16_swap_b32 v24, v22
    v_permlane16_swap_b32 v25, v23
    v_add_f32 v24, v24, v22
    v_add_f32 v25, v25, v23
    v_mov_b32 v22, v24
    v_mov_b32 v23, v25
    s_nop 0
    v_permlane32_swap_b32 v24, v22
    v_permlane32_swap_b32 v25, v23
    v_add_f32 v24, v24, v22
    v_add_f32 v25, v25, v23
    v_mov_b32 v20, 0x3727c5ac
    v_mov_b32 v21, 0x3727c5ac
    v_fmac_f32 v20, s27, v24
    v_fmac_f32 v21, s27, v25
    v_rsq_f32 v20, v20
    v_rsq_f32 v21, v21
    v_mul_f32 v32, v32, v20
    v_mul_f32 v33, v33, v20
    v_mul_f32 v34, v34, v20
    v_mul_f32 v35, v35, v20
    v_mul_f32 v36, v36, v20
    v_mul_f32 v37, v37, v20
    v_mul_f32 v38, v38, v20
    v_mul_f32 v39, v39, v20
    v_cvt_pk_bf16_f32 v8, v32, v33
    v_cvt_pk_bf16_f32 v9, v34, v35
    v_cvt_pk_bf16_f32 v10, v36, v37
    v_cvt_pk_bf16_f32 v11, v38, v39
    v_mul_f32 v40, v40, v21
    v_mul_f32 v41, v41, v21
    v_mul_f32 v42, v42, v21
    v_mul_f32 v43, v43, v21
    v_mul_f32 v44, v44, v21
    v_mul_f32 v45, v45, v21
    v_mul_f32 v46, v46, v21
    v_mul_f32 v47, v47, v21
    v_cvt_pk_bf16_f32 v12, v40, v41
    v_cvt_pk_bf16_f32 v13, v42, v43
    v_cvt_pk_bf16_f32 v14, v44, v45
    v_cvt_pk_bf16_f32 v15, v46, v47
    s_mov_b32 exec_hi, 0x00ffffff
    ds_write_b128 v2, v[8:11] offset:5632
    ds_write_b128 v2, v[12:15] offset:6528
    s_mov_b64 exec, -1
L_qnoln:
    v_lshrrev_b32 v6, 4, v1
    v_and_b32 v5, 1, v1
    v_mul_u32_u24 v7, 896, v5
    v_lshl_add_u32 v7, v6, 4, v7
    v_lshrrev_b32 v26, 4, v1
    v_lshlrev_b32 v26, 3, v26
    v_bfe_u32 v30, v1, 2, 2
    v_add_u32 v26, v26, v30
    v_lshlrev_b32 v26, 7, v26
    v_and_b32 v30, 3, v1
    v_lshl_add_u32 v26, v30, 3, v26
    v_bfe_u32 v27, v1, 3, 2
    v_xor_b32 v27, s3, v27
    v_lshl_add_u32 v26, v27, 5, v26
    v_add_u32 v26, 16384, v26
    v_lshlrev_b32 v28, 14, v5
    v_lshl_add_u32 v28, v6, 4, v28
    s_lshl_b32 s24, s29, 8
    s_lshl_b32 s25, s3, 6
    s_add_u32 s24, s24, s25
    s_add_u32 s24, s24, 4096
    s_waitcnt vmcnt(6) lgkmcnt(0)
    s_xor_b32 s60, s56, 0x9e3779b9
    s_barrier
    ds_read_b64_tr_b16 v[128:129], v26 offset:0
    ds_read_b64_tr_b16 v[130:131], v26 offset:512
    ds_read_b64_tr_b16 v[132:133], v26 offset:4096
    ds_read_b64_tr_b16 v[134:135], v26 offset:4608
    ds_read_b64_tr_b16 v[136:137], v26 offset:8192
    ds_read_b64_tr_b16 v[138:139], v26 offset:8704
    ds_read_b64_tr_b16 v[140:141], v26 offset:12288
    ds_read_b64_tr_b16 v[142:143], v26 offset:12800
    ds_read_b64_tr_b16 v[144:145], v26 offset:16384
    ds_read_b64_tr_b16 v[146:147], v26 offset:16896
    ds_read_b64_tr_b16 v[148:149], v26 offset:20480
    ds_read_b64_tr_b16 v[150:151], v26 offset:20992
    ds_read_b64_tr_b16 v[152:153], v26 offset:24576
    ds_read_b64_tr_b16 v[154:155], v26 offset:25088
    s_waitcnt lgkmcnt(7)
    ds_read_b128 v[192:195], v7 offset:5632
    ds_read_b128 v[196:199], v7 offset:5696
    ds_read_b128 v[200:203], v7 offset:5760
    ds_read_b128 v[204:207], v7 offset:5824
    ds_read_b128 v[208:211], v7 offset:5888
    ds_read_b128 v[212:215], v7 offset:5952
    ds_read_b128 v[216:219], v7 offset:6016
    s_waitcnt lgkmcnt(0)
    v_mfma_f32_16x16x32_bf16 v[8:11], v[128:131], v[192:195], 0
    v_mfma_f32_16x16x32_bf16 v[8:11], v[132:135], v[196:199], v[8:11]
    v_mfma_f32_16x16x32_bf16 v[8:11], v[136:139], v[200:203], v[8:11]
    v_mfma_f32_16x16x32_bf16 v[8:11], v[140:143], v[204:207], v[8:11]
    v_mfma_f32_16x16x32_bf16 v[8:11], v[144:147], v[208:211], v[8:11]
    v_mfma_f32_16x16x32_bf16 v[8:11], v[148:151], v[212:215], v[8:11]
    v_mfma_f32_16x16x32_bf16 v[8:11], v[152:155], v[216:219], v[8:11]
    ds_read_b64_tr_b16 v[156:157], v26 offset:28672
    ds_read_b64_tr_b16 v[158:159], v26 offset:29184
    ds_read_b64_tr_b16 v[160:161], v26 offset:32768
    ds_read_b64_tr_b16 v[162:163], v26 offset:33280
    ds_read_b64_tr_b16 v[164:165], v26 offset:36864
    ds_read_b64_tr_b16 v[166:167], v26 offset:37376
    ds_read_b64_tr_b16 v[168:169], v26 offset:40960
    ds_read_b64_tr_b16 v[170:171], v26 offset:41472
    ds_read_b64_tr_b16 v[172:173], v26 offset:45056
    ds_read_b64_tr_b16 v[174:175], v26 offset:45568
    ds_read_b64_tr_b16 v[176:177], v26 offset:49152
    ds_read_b64_tr_b16 v[178:179], v26 offset:49664
    ds_read_b64_tr_b16 v[180:181], v26 offset:53248
    ds_read_b64_tr_b16 v[182:183], v26 offset:53760
    s_waitcnt lgkmcnt(7)
    ds_read_b128 v[220:223], v7 offset:6080
    ds_read_b128 v[224:227], v7 offset:6144
    ds_read_b128 v[228:231], v7 offset:6208
    ds_read_b128 v[232:235], v7 offset:6272
    ds_read_b128 v[236:239], v7 offset:6336
    ds_read_b128 v[240:243], v7 offset:6400
    ds_read_b128 v[244:247], v7 offset:6464
    s_waitcnt lgkmcnt(0)
    v_mfma_f32_16x16x32_bf16 v[8:11], v[156:159], v[220:223], v[8:11]
    v_mfma_f32_16x16x32_bf16 v[8:11], v[160:163], v[224:227], v[8:11]
    v_mfma_f32_16x16x32_bf16 v[8:11], v[164:167], v[228:231], v[8:11]
    v_mfma_f32_16x16x32_bf16 v[8:11], v[168:171], v[232:235], v[8:11]
    v_mfma_f32_16x16x32_bf16 v[8:11], v[172:175], v[236:239], v[8:11]
    v_mfma_f32_16x16x32_bf16 v[8:11], v[176:179], v[240:243], v[8:11]
    v_mfma_f32_16x16x32_bf16 v[8:11], v[180:183], v[244:247], v[8:11]
    v_mov_b32 v13, s60
    v_mov_b32 v15, s60
    s_nop 5
    v_cvt_pk_bf16_f32 v12, v8, v9
    v_cvt_pk_bf16_f32 v14, v10, v11
    s_mov_b32 exec_lo, 0x00030003
    s_mov_b32 exec_hi, 0x00030003
    buffer_store_dwordx4 v[12:15], v28, s[8:11], s24 offen sc1
    s_mov_b64 exec, -1
L_qback:
    s_mul_i32 s25, s3, 1280
    v_lshl_add_u32 v61, v1, 4, s25
    v_lshl_add_u32 v60, v1, 2, s25
    v_mov_b32 v16, 0xff800000
    v_mov_b32 v17, 0xff800000
    v_mov_b32 v18, 0xff800000
    v_mov_b32 v19, 0xff800000
    ds_write_b128 v61, v[16:19] offset:0
    ds_write_b32 v60, v16 offset:1024
    v_lshrrev_b32 v3, 5, v1
    v_mul_u32_u24 v3, 640, v3
    v_add_u32 v3, s25, v3
    v_mov_b32 v62, v3
    v_bfe_u32 v20, v1, 2, 3
    v_lshl_add_u32 v3, v20, 2, v3
    v_and_b32 v20, 31, v1
    v_lshlrev_b32 v20, 4, v20
    s_add_u32 s20, s36, s85
    s_addc_u32 s21, s37, 0
    s_waitcnt vmcnt(5)
    buffer_load_dwordx4 v[88:91], v2, s[4:7], s22 offen nt
    s_addk_i32 s22, 0x1000
    s_waitcnt vmcnt(5)
    buffer_load_dwordx4 v[92:95], v2, s[4:7], s22 offen nt
    s_addk_i32 s22, 0x1000
    s_waitcnt vmcnt(5)
    buffer_load_dwordx4 v[96:99], v2, s[4:7], s22 offen nt
    s_addk_i32 s22, 0x1000
    s_waitcnt vmcnt(5)
    buffer_load_dwordx4 v[100:103], v2, s[4:7], s22 offen nt
    s_addk_i32 s22, 0x1000
    s_waitcnt vmcnt(5)
    buffer_load_dwordx4 v[104:107], v2, s[4:7], s22 offen nt
    s_addk_i32 s22, 0x1000
    s_waitcnt vmcnt(5)
    buffer_load_dwordx4 v[108:111], v2, s[4:7], s22 offen nt
    s_addk_i32 s22, 0x1000
    s_waitcnt vmcnt(5)
    buffer_load_dwordx4 v[112:115], v2, s[4:7], s22 offen nt
    s_addk_i32 s22, 0x1000
    s_waitcnt vmcnt(5)
    buffer_load_dwordx4 v[116:119], v2, s[4:7], s22 offen nt
    s_addk_i32 s22, 0x1000
    s_waitcnt vmcnt(5)
    buffer_load_dwordx4 v[120:123], v2, s[4:7], s22 offen nt
    s_addk_i32 s22, 0x1000
    s_waitcnt vmcnt(5)
    buffer_load_dwordx4 v[124:127], v2, s[4:7], s22 offen nt
    s_addk_i32 s22, 0x1000
    s_waitcnt vmcnt(5)
    buffer_load_dwordx4 v[128:131], v2, s[4:7], s22 offen nt
    s_addk_i32 s22, 0x1000
    s_waitcnt vmcnt(5)
    buffer_load_dwordx4 v[132:135], v2, s[4:7], s22 offen nt
    s_addk_i32 s22, 0x1000
    s_waitcnt vmcnt(5)
    buffer_load_dwordx4 v[136:139], v2, s[4:7], s22 offen nt
    s_addk_i32 s22, 0x1000
    s_waitcnt vmcnt(5)
    buffer_load_dwordx4 v[140:143], v2, s[4:7], s22 offen nt
    s_addk_i32 s22, 0x1000
    s_waitcnt vmcnt(5)
    buffer_load_dwordx4 v[144:147], v2, s[4:7], s22 offen nt
    s_addk_i32 s22, 0x1000
    s_waitcnt vmcnt(5)
    buffer_load_dwordx4 v[148:151], v2, s[4:7], s22 offen nt
    s_addk_i32 s22, 0x1000
    s_waitcnt vmcnt(5)
    buffer_load_dwordx4 v[152:155], v2, s[4:7], s22 offen nt
    s_addk_i32 s22, 0x1000
    s_waitcnt vmcnt(5)
    buffer_load_dwordx4 v[156:159], v2, s[4:7], s22 offen nt
    s_addk_i32 s22, 0x1000
    s_waitcnt vmcnt(5)
    buffer_load_dwordx4 v[160:163], v2, s[4:7], s22 offen nt
    s_addk_i32 s22, 0x1000
    s_waitcnt vmcnt(5)
    buffer_load_dwordx4 v[164:167], v2, s[4:7], s22 offen nt
    s_addk_i32 s22, 0x1000
    s_waitcnt vmcnt(5)
    buffer_load_dwordx4 v[168:171], v2, s[4:7], s22 offen nt
    s_addk_i32 s22, 0x1000
    s_waitcnt vmcnt(5)
    buffer_load_dwordx4 v[172:175], v2, s[4:7], s22 offen nt
    s_addk_i32 s22, 0x1000
    s_waitcnt vmcnt(5)
    s_barrier
    buffer_load_dwordx4 v[176:179], v2, s[4:7], s22 offen nt
    s_addk_i32 s22, 0x1000
    s_waitcnt vmcnt(5)
    buffer_load_dwordx4 v[180:183], v2, s[4:7], s22 offen nt
    s_addk_i32 s22, 0x1000
    s_waitcnt vmcnt(5)
    buffer_load_dwordx4 v[184:187], v2, s[4:7], s22 offen nt
    s_addk_i32 s22, 0x1000
    s_waitcnt vmcnt(5)
    buffer_load_dwordx4 v[188:191], v2, s[4:7], s22 offen nt
    s_addk_i32 s22, 0x1000
    s_waitcnt vmcnt(5)
    buffer_load_dwordx4 v[192:195], v2, s[4:7], s22 offen nt
    s_addk_i32 s22, 0x1000
    s_waitcnt vmcnt(5)
    buffer_load_dwordx4 v[196:199], v2, s[4:7], s22 offen nt
    s_addk_i32 s22, 0x1000
    s_waitcnt vmcnt(5)
    buffer_load_dwordx4 v[200:203], v2, s[4:7], s22 offen nt
    s_addk_i32 s22, 0x1000
    s_waitcnt vmcnt(5)
    buffer_load_dwordx4 v[204:207], v2, s[4:7], s22 offen nt
    s_addk_i32 s22, 0x1000
    s_waitcnt vmcnt(5)
    buffer_load_dwordx4 v[208:211], v2, s[4:7], s22 offen nt
    s_addk_i32 s22, 0x1000
    s_waitcnt vmcnt(5)
    buffer_load_dwordx4 v[212:215], v2, s[4:7], s22 offen nt
    s_addk_i32 s22, 0x1000
    s_waitcnt vmcnt(5)
    buffer_load_dwordx4 v[216:219], v2, s[4:7], s22 offen nt
    s_addk_i32 s22, 0x1000
    s_waitcnt vmcnt(5)
    buffer_load_dwordx4 v[220:223], v2, s[4:7], s22 offen nt
    s_addk_i32 s22, 0x1000
    s_waitcnt vmcnt(5)
    buffer_load_dwordx4 v[224:227], v2, s[4:7], s22 offen nt
    s_addk_i32 s22, 0x1000
    s_waitcnt vmcnt(5)
    buffer_load_dwordx4 v[228:231], v2, s[4:7], s22 offen nt
    s_addk_i32 s22, 0x1000
    s_waitcnt vmcnt(5)
    buffer_load_dwordx4 v[232:235], v2, s[4:7], s22 offen nt
    s_addk_i32 s22, 0x1000
    s_waitcnt vmcnt(5)
    buffer_load_dwordx4 v[236:239], v2, s[4:7], s22 offen nt
    s_addk_i32 s22, 0x1000
    s_waitcnt vmcnt(5)
    buffer_load_dwordx4 v[240:243], v2, s[4:7], s22 offen nt
    s_addk_i32 s22, 0x1000
    s_waitcnt vmcnt(5)
    buffer_load_dwordx4 v[244:247], v2, s[4:7], s22 offen nt
    s_addk_i32 s22, 0x1000
    s_waitcnt vmcnt(5)
    buffer_load_dwordx4 v[248:251], v2, s[4:7], s22 offen nt
    s_addk_i32 s22, 0x1000
    s_waitcnt vmcnt(5)
    buffer_load_dwordx4 v[252:255], v2, s[4:7], s22 offen nt
    s_addk_i32 s22, 0x1000
    s_barrier
    ds_read_b128 v[4:7], v20 offset:5120
    s_waitcnt lgkmcnt(0)
    s_waitcnt vmcnt(47)
    v_dot2_f32_bf16 v8, v64, v4, 0
    v_dot2_f32_bf16 v8, v65, v5, v8
    v_dot2_f32_bf16 v8, v66, v6, v8
    v_dot2_f32_bf16 v8, v67, v7, v8
    buffer_load_dwordx4 v[64:67], v2, s[4:7], s22 offen nt
    s_addk_i32 s22, 0x1000
    s_waitcnt vmcnt(47)
    v_dot2_f32_bf16 v9, v68, v4, 0
    v_dot2_f32_bf16 v9, v69, v5, v9
    v_dot2_f32_bf16 v9, v70, v6, v9
    v_dot2_f32_bf16 v9, v71, v7, v9
    buffer_load_dwordx4 v[68:71], v2, s[4:7], s22 offen nt
    s_addk_i32 s22, 0x1000
    s_waitcnt vmcnt(47)
    v_dot2_f32_bf16 v10, v72, v4, 0
    v_dot2_f32_bf16 v10, v73, v5, v10
    v_dot2_f32_bf16 v10, v74, v6, v10
    v_dot2_f32_bf16 v10, v75, v7, v10
    buffer_load_dwordx4 v[72:75], v2, s[4:7], s22 offen nt
    s_addk_i32 s22, 0x1000
    s_waitcnt vmcnt(47)
    v_dot2_f32_bf16 v11, v76, v4, 0
    v_dot2_f32_bf16 v11, v77, v5, v11
    v_dot2_f32_bf16 v11, v78, v6, v11
    v_dot2_f32_bf16 v11, v79, v7, v11
    buffer_load_dwordx4 v[76:79], v2, s[4:7], s22 offen nt
    s_addk_i32 s22, 0x1000
    s_waitcnt vmcnt(47)
    v_dot2_f32_bf16 v12, v80, v4, 0
    v_dot2_f32_bf16 v12, v81, v5, v12
    v_dot2_f32_bf16 v12, v82, v6, v12
    v_dot2_f32_bf16 v12, v83, v7, v12
    buffer_load_dwordx4 v[80:83], v2, s[4:7], s22 offen nt
    s_addk_i32 s22, 0x1000
    s_waitcnt vmcnt(47)
    v_dot2_f32_bf16 v13, v84, v4, 0
    v_dot2_f32_bf16 v13, v85, v5, v13
    v_dot2_f32_bf16 v13, v86, v6, v13
    v_dot2_f32_bf16 v13, v87, v7, v13
    buffer_load_dwordx4 v[84:87], v2, s[4:7], s22 offen nt
    s_addk_i32 s22, 0x1000
    s_waitcnt vmcnt(47)
    v_dot2_f32_bf16 v14, v88, v4, 0
    v_dot2_f32_bf16 v14, v89, v5, v14
    v_dot2_f32_bf16 v14, v90, v6, v14
    v_dot2_f32_bf16 v14, v91, v7, v14
    buffer_load_dwordx4 v[88:91], v2, s[4:7], s22 offen nt
    s_addk_i32 s22, 0x1000
    s_waitcnt vmcnt(47)
    v_dot2_f32_bf16 v15, v92, v4, 0
    v_dot2_f32_bf16 v15, v93, v5, v15
    v_dot2_f32_bf16 v15, v94, v6, v15
    v_dot2_f32_bf16 v15, v95, v7, v15
    buffer_load_dwordx4 v[92:95], v2, s[4:7], s22 offen nt
    s_addk_i32 s22, 0x1000
    v_permlane16_swap_b32 v8, v12
    v_permlane16_swap_b32 v9, v13
    v_permlane16_swap_b32 v10, v14
    v_permlane16_swap_b32 v11, v15
    v_add_f32 v8, v8, v12
    v_add_f32 v9, v9, v13
    v_add_f32 v10, v10, v14
    v_add_f32 v11, v11, v15
    v_add_f32_dpp v8, v8, v8 row_ror:8 row_mask:0xf bank_mask:0x3
    v_add_f32_dpp v9, v9, v9 row_ror:8 row_mask:0xf bank_mask:0x3
    s_nop 0
    v_add_f32_dpp v8, v10, v10 row_ror:8 row_mask:0xf bank_mask:0xc
    v_add_f32_dpp v9, v11, v11 row_ror:8 row_mask:0xf bank_mask:0xc
    s_nop 0
    v_add_f32_dpp v8, v8, v8 row_half_mirror row_mask:0xf bank_mask:0x5
    s_nop 1
    v_add_f32_dpp v8, v9, v9 row_half_mirror row_mask:0xf bank_mask:0xa
    s_nop 1
    v_add_f32_dpp v8, v8, v8 quad_perm:[1,0,3,2] row_mask:0xf bank_mask:0xf
    s_nop 1
    v_add_f32_dpp v8, v8, v8 quad_perm:[2,3,0,1] row_mask:0xf bank_mask:0xf
    ds_write_b32 v3, v8 offset:0
    s_waitcnt vmcnt(47)
    v_dot2_f32_bf16 v8, v96, v4, 0
    v_dot2_f32_bf16 v8, v97, v5, v8
    v_dot2_f32_bf16 v8, v98, v6, v8
    v_dot2_f32_bf16 v8, v99, v7, v8
    s_waitcnt vmcnt(46)
    v_dot2_f32_bf16 v9, v100, v4, 0
    v_dot2_f32_bf16 v9, v101, v5, v9
    v_dot2_f32_bf16 v9, v102, v6, v9
    v_dot2_f32_bf16 v9, v103, v7, v9
    s_waitcnt vmcnt(45)
    v_dot2_f32_bf16 v10, v104, v4, 0
    v_dot2_f32_bf16 v10, v105, v5, v10
    v_dot2_f32_bf16 v10, v106, v6, v10
    v_dot2_f32_bf16 v10, v107, v7, v10
    s_waitcnt vmcnt(44)
    v_dot2_f32_bf16 v11, v108, v4, 0
    v_dot2_f32_bf16 v11, v109, v5, v11
    v_dot2_f32_bf16 v11, v110, v6, v11
    v_dot2_f32_bf16 v11, v111, v7, v11
    s_waitcnt vmcnt(43)
    v_dot2_f32_bf16 v12, v112, v4, 0
    v_dot2_f32_bf16 v12, v113, v5, v12
    v_dot2_f32_bf16 v12, v114, v6, v12
    v_dot2_f32_bf16 v12, v115, v7, v12
    s_waitcnt vmcnt(42)
    v_dot2_f32_bf16 v13, v116, v4, 0
    v_dot2_f32_bf16 v13, v117, v5, v13
    v_dot2_f32_bf16 v13, v118, v6, v13
    v_dot2_f32_bf16 v13, v119, v7, v13
    s_waitcnt vmcnt(41)
    v_dot2_f32_bf16 v14, v120, v4, 0
    v_dot2_f32_bf16 v14, v121, v5, v14
    v_dot2_f32_bf16 v14, v122, v6, v14
    v_dot2_f32_bf16 v14, v123, v7, v14
    s_waitcnt vmcnt(40)
    v_dot2_f32_bf16 v15, v124, v4, 0
    v_dot2_f32_bf16 v15, v125, v5, v15
    v_dot2_f32_bf16 v15, v126, v6, v15
    v_dot2_f32_bf16 v15, v127, v7, v15
    v_permlane16_swap_b32 v8, v12
    v_permlane16_swap_b32 v9, v13
    v_permlane16_swap_b32 v10, v14
    v_permlane16_swap_b32 v11, v15
    v_add_f32 v8, v8, v12
    v_add_f32 v9, v9, v13
    v_add_f32 v10, v10, v14
    v_add_f32 v11, v11, v15
    v_add_f32_dpp v8, v8, v8 row_ror:8 row_mask:0xf bank_mask:0x3
    v_add_f32_dpp v9, v9, v9 row_ror:8 row_mask:0xf bank_mask:0x3
    s_nop 0
    v_add_f32_dpp v8, v10, v10 row_ror:8 row_mask:0xf bank_mask:0xc
    v_add_f32_dpp v9, v11, v11 row_ror:8 row_mask:0xf bank_mask:0xc
    s_nop 0
    v_add_f32_dpp v8, v8, v8 row_half_mirror row_mask:0xf bank_mask:0x5
    s_nop 1
    v_add_f32_dpp v8, v9, v9 row_half_mirror row_mask:0xf bank_mask:0xa
    s_nop 1
    v_add_f32_dpp v8, v8, v8 quad_perm:[1,0,3,2] row_mask:0xf bank_mask:0xf
    s_nop 1
    v_add_f32_dpp v8, v8, v8 quad_perm:[2,3,0,1] row_mask:0xf bank_mask:0xf
    ds_write_b32 v3, v8 offset:32
    s_waitcnt vmcnt(39)
    v_dot2_f32_bf16 v8, v128, v4, 0
    v_dot2_f32_bf16 v8, v129, v5, v8
    v_dot2_f32_bf16 v8, v130, v6, v8
    v_dot2_f32_bf16 v8, v131, v7, v8
    s_waitcnt vmcnt(38)
    v_dot2_f32_bf16 v9, v132, v4, 0
    v_dot2_f32_bf16 v9, v133, v5, v9
    v_dot2_f32_bf16 v9, v134, v6, v9
    v_dot2_f32_bf16 v9, v135, v7, v9
    s_waitcnt vmcnt(37)
    v_dot2_f32_bf16 v10, v136, v4, 0
    v_dot2_f32_bf16 v10, v137, v5, v10
    v_dot2_f32_bf16 v10, v138, v6, v10
    v_dot2_f32_bf16 v10, v139, v7, v10
    s_waitcnt vmcnt(36)
    v_dot2_f32_bf16 v11, v140, v4, 0
    v_dot2_f32_bf16 v11, v141, v5, v11
    v_dot2_f32_bf16 v11, v142, v6, v11
    v_dot2_f32_bf16 v11, v143, v7, v11
    s_waitcnt vmcnt(35)
    v_dot2_f32_bf16 v12, v144, v4, 0
    v_dot2_f32_bf16 v12, v145, v5, v12
    v_dot2_f32_bf16 v12, v146, v6, v12
    v_dot2_f32_bf16 v12, v147, v7, v12
    s_waitcnt vmcnt(34)
    v_dot2_f32_bf16 v13, v148, v4, 0
    v_dot2_f32_bf16 v13, v149, v5, v13
    v_dot2_f32_bf16 v13, v150, v6, v13
    v_dot2_f32_bf16 v13, v151, v7, v13
    s_waitcnt vmcnt(33)
    v_dot2_f32_bf16 v14, v152, v4, 0
    v_dot2_f32_bf16 v14, v153, v5, v14
    v_dot2_f32_bf16 v14, v154, v6, v14
    v_dot2_f32_bf16 v14, v155, v7, v14
    s_waitcnt vmcnt(32)
    v_dot2_f32_bf16 v15, v156, v4, 0
    v_dot2_f32_bf16 v15, v157, v5, v15
    v_dot2_f32_bf16 v15, v158, v6, v15
    v_dot2_f32_bf16 v15, v159, v7, v15
    v_permlane16_swap_b32 v8, v12
    v_permlane16_swap_b32 v9, v13
    v_permlane16_swap_b32 v10, v14
    v_permlane16_swap_b32 v11, v15
    v_add_f32 v8, v8, v12
    v_add_f32 v9, v9, v13
    v_add_f32 v10, v10, v14
    v_add_f32 v11, v11, v15
    v_add_f32_dpp v8, v8, v8 row_ror:8 row_mask:0xf bank_mask:0x3
    v_add_f32_dpp v9, v9, v9 row_ror:8 row_mask:0xf bank_mask:0x3
    s_nop 0
    v_add_f32_dpp v8, v10, v10 row_ror:8 row_mask:0xf bank_mask:0xc
    v_add_f32_dpp v9, v11, v11 row_ror:8 row_mask:0xf bank_mask:0xc
    s_nop 0
    v_add_f32_dpp v8, v8, v8 row_half_mirror row_mask:0xf bank_mask:0x5
    s_nop 1
    v_add_f32_dpp v8, v9, v9 row_half_mirror row_mask:0xf bank_mask:0xa
    s_nop 1
    v_add_f32_dpp v8, v8, v8 quad_perm:[1,0,3,2] row_mask:0xf bank_mask:0xf
    s_nop 1
    v_add_f32_dpp v8, v8, v8 quad_perm:[2,3,0,1] row_mask:0xf bank_mask:0xf
    ds_write_b32 v3, v8 offset:64
    s_waitcnt vmcnt(31)
    v_dot2_f32_bf16 v8, v160, v4, 0
    v_dot2_f32_bf16 v8, v161, v5, v8
    v_dot2_f32_bf16 v8, v162, v6, v8
    v_dot2_f32_bf16 v8, v163, v7, v8
    s_waitcnt vmcnt(30)
    v_dot2_f32_bf16 v9, v164, v4, 0
    v_dot2_f32_bf16 v9, v165, v5, v9
    v_dot2_f32_bf16 v9, v166, v6, v9
    v_dot2_f32_bf16 v9, v167, v7, v9
    s_waitcnt vmcnt(29)
    v_dot2_f32_bf16 v10, v168, v4, 0
    v_dot2_f32_bf16 v10, v169, v5, v10
    v_dot2_f32_bf16 v10, v170, v6, v10
    v_dot2_f32_bf16 v10, v171, v7, v10
    s_waitcnt vmcnt(28)
    v_dot2_f32_bf16 v11, v172, v4, 0
    v_dot2_f32_bf16 v11, v173, v5, v11
    v_dot2_f32_bf16 v11, v174, v6, v11
    v_dot2_f32_bf16 v11, v175, v7, v11
    s_waitcnt vmcnt(27)
    v_dot2_f32_bf16 v12, v176, v4, 0
    v_dot2_f32_bf16 v12, v177, v5, v12
    v_dot2_f32_bf16 v12, v178, v6, v12
    v_dot2_f32_bf16 v12, v179, v7, v12
    s_waitcnt vmcnt(26)
    v_dot2_f32_bf16 v13, v180, v4, 0
    v_dot2_f32_bf16 v13, v181, v5, v13
    v_dot2_f32_bf16 v13, v182, v6, v13
    v_dot2_f32_bf16 v13, v183, v7, v13
    s_waitcnt vmcnt(25)
    v_dot2_f32_bf16 v14, v184, v4, 0
    v_dot2_f32_bf16 v14, v185, v5, v14
    v_dot2_f32_bf16 v14, v186, v6, v14
    v_dot2_f32_bf16 v14, v187, v7, v14
    s_waitcnt vmcnt(24)
    v_dot2_f32_bf16 v15, v188, v4, 0
    v_dot2_f32_bf16 v15, v189, v5, v15
    v_dot2_f32_bf16 v15, v190, v6, v15
    v_dot2_f32_bf16 v15, v191, v7, v15
    v_permlane16_swap_b32 v8, v12
    v_permlane16_swap_b32 v9, v13
    v_permlane16_swap_b32 v10, v14
    v_permlane16_swap_b32 v11, v15
    v_add_f32 v8, v8, v12
    v_add_f32 v9, v9, v13
    v_add_f32 v10, v10, v14
    v_add_f32 v11, v11, v15
    v_add_f32_dpp v8, v8, v8 row_ror:8 row_mask:0xf bank_mask:0x3
    v_add_f32_dpp v9, v9, v9 row_ror:8 row_mask:0xf bank_mask:0x3
    s_nop 0
    v_add_f32_dpp v8, v10, v10 row_ror:8 row_mask:0xf bank_mask:0xc
    v_add_f32_dpp v9, v11, v11 row_ror:8 row_mask:0xf bank_mask:0xc
    s_nop 0
    v_add_f32_dpp v8, v8, v8 row_half_mirror row_mask:0xf bank_mask:0x5
    s_nop 1
    v_add_f32_dpp v8, v9, v9 row_half_mirror row_mask:0xf bank_mask:0xa
    s_nop 1
    v_add_f32_dpp v8, v8, v8 quad_perm:[1,0,3,2] row_mask:0xf bank_mask:0xf
    s_nop 1
    v_add_f32_dpp v8, v8, v8 quad_perm:[2,3,0,1] row_mask:0xf bank_mask:0xf
    ds_write_b32 v3, v8 offset:96
    s_waitcnt vmcnt(23)
    v_dot2_f32_bf16 v8, v192, v4, 0
    v_dot2_f32_bf16 v8, v193, v5, v8
    v_dot2_f32_bf16 v8, v194, v6, v8
    v_dot2_f32_bf16 v8, v195, v7, v8
    s_waitcnt vmcnt(22)
    v_dot2_f32_bf16 v9, v196, v4, 0
    v_dot2_f32_bf16 v9, v197, v5, v9
    v_dot2_f32_bf16 v9, v198, v6, v9
    v_dot2_f32_bf16 v9, v199, v7, v9
    s_waitcnt vmcnt(21)
    v_dot2_f32_bf16 v10, v200, v4, 0
    v_dot2_f32_bf16 v10, v201, v5, v10
    v_dot2_f32_bf16 v10, v202, v6, v10
    v_dot2_f32_bf16 v10, v203, v7, v10
    s_waitcnt vmcnt(20)
    v_dot2_f32_bf16 v11, v204, v4, 0
    v_dot2_f32_bf16 v11, v205, v5, v11
    v_dot2_f32_bf16 v11, v206, v6, v11
    v_dot2_f32_bf16 v11, v207, v7, v11
    s_waitcnt vmcnt(19)
    v_dot2_f32_bf16 v12, v208, v4, 0
    v_dot2_f32_bf16 v12, v209, v5, v12
    v_dot2_f32_bf16 v12, v210, v6, v12
    v_dot2_f32_bf16 v12, v211, v7, v12
    s_waitcnt vmcnt(18)
    v_dot2_f32_bf16 v13, v212, v4, 0
    v_dot2_f32_bf16 v13, v213, v5, v13
    v_dot2_f32_bf16 v13, v214, v6, v13
    v_dot2_f32_bf16 v13, v215, v7, v13
    s_waitcnt vmcnt(17)
    v_dot2_f32_bf16 v14, v216, v4, 0
    v_dot2_f32_bf16 v14, v217, v5, v14
    v_dot2_f32_bf16 v14, v218, v6, v14
    v_dot2_f32_bf16 v14, v219, v7, v14
    s_waitcnt vmcnt(16)
    v_dot2_f32_bf16 v15, v220, v4, 0
    v_dot2_f32_bf16 v15, v221, v5, v15
    v_dot2_f32_bf16 v15, v222, v6, v15
    v_dot2_f32_bf16 v15, v223, v7, v15
    v_permlane16_swap_b32 v8, v12
    v_permlane16_swap_b32 v9, v13
    v_permlane16_swap_b32 v10, v14
    v_permlane16_swap_b32 v11, v15
    v_add_f32 v8, v8, v12
    v_add_f32 v9, v9, v13
    v_add_f32 v10, v10, v14
    v_add_f32 v11, v11, v15
    v_add_f32_dpp v8, v8, v8 row_ror:8 row_mask:0xf bank_mask:0x3
    v_add_f32_dpp v9, v9, v9 row_ror:8 row_mask:0xf bank_mask:0x3
    s_nop 0
    v_add_f32_dpp v8, v10, v10 row_ror:8 row_mask:0xf bank_mask:0xc
    v_add_f32_dpp v9, v11, v11 row_ror:8 row_mask:0xf bank_mask:0xc
    s_nop 0
    v_add_f32_dpp v8, v8, v8 row_half_mirror row_mask:0xf bank_mask:0x5
    s_nop 1
    v_add_f32_dpp v8, v9, v9 row_half_mirror row_mask:0xf bank_mask:0xa
    s_nop 1
    v_add_f32_dpp v8, v8, v8 quad_perm:[1,0,3,2] row_mask:0xf bank_mask:0xf
    s_nop 1
    v_add_f32_dpp v8, v8, v8 quad_perm:[2,3,0,1] row_mask:0xf bank_mask:0xf
    ds_write_b32 v3, v8 offset:128
    s_waitcnt vmcnt(15)
    v_dot2_f32_bf16 v8, v224, v4, 0
    v_dot2_f32_bf16 v8, v225, v5, v8
    v_dot2_f32_bf16 v8, v226, v6, v8
    v_dot2_f32_bf16 v8, v227, v7, v8
    s_waitcnt vmcnt(14)
    v_dot2_f32_bf16 v9, v228, v4, 0
    v_dot2_f32_bf16 v9, v229, v5, v9
    v_dot2_f32_bf16 v9, v230, v6, v9
    v_dot2_f32_bf16 v9, v231, v7, v9
    s_waitcnt vmcnt(13)
    v_dot2_f32_bf16 v10, v232, v4, 0
    v_dot2_f32_bf16 v10, v233, v5, v10
    v_dot2_f32_bf16 v10, v234, v6, v10
    v_dot2_f32_bf16 v10, v235, v7, v10
    s_waitcnt vmcnt(12)
    v_dot2_f32_bf16 v11, v236, v4, 0
    v_dot2_f32_bf16 v11, v237, v5, v11
    v_dot2_f32_bf16 v11, v238, v6, v11
    v_dot2_f32_bf16 v11, v239, v7, v11
    s_waitcnt vmcnt(11)
    v_dot2_f32_bf16 v12, v240, v4, 0
    v_dot2_f32_bf16 v12, v241, v5, v12
    v_dot2_f32_bf16 v12, v242, v6, v12
    v_dot2_f32_bf16 v12, v243, v7, v12
    s_waitcnt vmcnt(10)
    v_dot2_f32_bf16 v13, v244, v4, 0
    v_dot2_f32_bf16 v13, v245, v5, v13
    v_dot2_f32_bf16 v13, v246, v6, v13
    v_dot2_f32_bf16 v13, v247, v7, v13
    s_waitcnt vmcnt(9)
    v_dot2_f32_bf16 v14, v248, v4, 0
    v_dot2_f32_bf16 v14, v249, v5, v14
    v_dot2_f32_bf16 v14, v250, v6, v14
    v_dot2_f32_bf16 v14, v251, v7, v14
    s_waitcnt vmcnt(8)
    v_dot2_f32_bf16 v15, v252, v4, 0
    v_dot2_f32_bf16 v15, v253, v5, v15
    v_dot2_f32_bf16 v15, v254, v6, v15
    v_dot2_f32_bf16 v15, v255, v7, v15
    v_permlane16_swap_b32 v8, v12
    v_permlane16_swap_b32 v9, v13
    v_permlane16_swap_b32 v10, v14
    v_permlane16_swap_b32 v11, v15
    v_add_f32 v8, v8, v12
    v_add_f32 v9, v9, v13
    v_add_f32 v10, v10, v14
    v_add_f32 v11, v11, v15
    v_add_f32_dpp v8, v8, v8 row_ror:8 row_mask:0xf bank_mask:0x3
    v_add_f32_dpp v9, v9, v9 row_ror:8 row_mask:0xf bank_mask:0x3
    s_nop 0
    v_add_f32_dpp v8, v10, v10 row_ror:8 row_mask:0xf bank_mask:0xc
    v_add_f32_dpp v9, v11, v11 row_ror:8 row_mask:0xf bank_mask:0xc
    s_nop 0
    v_add_f32_dpp v8, v8, v8 row_half_mirror row_mask:0xf bank_mask:0x5
    s_nop 1
    v_add_f32_dpp v8, v9, v9 row_half_mirror row_mask:0xf bank_mask:0xa
    s_nop 1
    v_add_f32_dpp v8, v8, v8 quad_perm:[1,0,3,2] row_mask:0xf bank_mask:0xf
    s_nop 1
    v_add_f32_dpp v8, v8, v8 quad_perm:[2,3,0,1] row_mask:0xf bank_mask:0xf
    ds_write_b32 v3, v8 offset:160
    s_sub_u32 s24, s84, 6
    v_add_u32 v3, 192, v3
L_kloop:
    s_cmp_lg_u32 s24, 1
    s_cbranch_scc1 L_kgo
    s_mov_b32 s4, s20
    s_mov_b32 s5, s21
    s_mov_b32 s22, s86
L_kgo:
    s_waitcnt vmcnt(7)
    v_dot2_f32_bf16 v8, v64, v4, 0
    v_dot2_f32_bf16 v8, v65, v5, v8
    v_dot2_f32_bf16 v8, v66, v6, v8
    v_dot2_f32_bf16 v8, v67, v7, v8
    buffer_load_dwordx4 v[64:67], v2, s[4:7], s22 offen nt
    s_addk_i32 s22, 0x1000
    s_waitcnt vmcnt(7)
    v_dot2_f32_bf16 v9, v68, v4, 0
    v_dot2_f32_bf16 v9, v69, v5, v9
    v_dot2_f32_bf16 v9, v70, v6, v9
    v_dot2_f32_bf16 v9, v71, v7, v9
    buffer_load_dwordx4 v[68:71], v2, s[4:7], s22 offen nt
    s_addk_i32 s22, 0x1000
    s_waitcnt vmcnt(7)
    v_dot2_f32_bf16 v10, v72, v4, 0
    v_dot2_f32_bf16 v10, v73, v5, v10
    v_dot2_f32_bf16 v10, v74, v6, v10
    v_dot2_f32_bf16 v10, v75, v7, v10
    buffer_load_dwordx4 v[72:75], v2, s[4:7], s22 offen nt
    s_addk_i32 s22, 0x1000
    s_waitcnt vmcnt(7)
    v_dot2_f32_bf16 v11, v76, v4, 0
    v_dot2_f32_bf16 v11, v77, v5, v11
    v_dot2_f32_bf16 v11, v78, v6, v11
    v_dot2_f32_bf16 v11, v79, v7, v11
    buffer_load_dwordx4 v[76:79], v2, s[4:7], s22 offen nt
    s_addk_i32 s22, 0x1000
    s_waitcnt vmcnt(7)
    v_dot2_f32_bf16 v12, v80, v4, 0
    v_dot2_f32_bf16 v12, v81, v5, v12
    v_dot2_f32_bf16 v12, v82, v6, v12
    v_dot2_f32_bf16 v12, v83, v7, v12
    buffer_load_dwordx4 v[80:83], v2, s[4:7], s22 offen nt
    s_addk_i32 s22, 0x1000
    s_waitcnt vmcnt(7)
    v_dot2_f32_bf16 v13, v84, v4, 0
    v_dot2_f32_bf16 v13, v85, v5, v13
    v_dot2_f32_bf16 v13, v86, v6, v13
    v_dot2_f32_bf16 v13, v87, v7, v13
    buffer_load_dwordx4 v[84:87], v2, s[4:7], s22 offen nt
    s_addk_i32 s22, 0x1000
    s_waitcnt vmcnt(7)
    v_dot2_f32_bf16 v14, v88, v4, 0
    v_dot2_f32_bf16 v14, v89, v5, v14
    v_dot2_f32_bf16 v14, v90, v6, v14
    v_dot2_f32_bf16 v14, v91, v7, v14
    buffer_load_dwordx4 v[88:91], v2, s[4:7], s22 offen nt
    s_addk_i32 s22, 0x1000
    s_waitcnt vmcnt(7)
    v_dot2_f32_bf16 v15, v92, v4, 0
    v_dot2_f32_bf16 v15, v93, v5, v15
    v_dot2_f32_bf16 v15, v94, v6, v15
    v_dot2_f32_bf16 v15, v95, v7, v15
    buffer_load_dwordx4 v[92:95], v2, s[4:7], s22 offen nt
    s_addk_i32 s22, 0x1000
    v_permlane16_swap_b32 v8, v12
    v_permlane16_swap_b32 v9, v13
    v_permlane16_swap_b32 v10, v14
    v_permlane16_swap_b32 v11, v15
    v_add_f32 v8, v8, v12
    v_add_f32 v9, v9, v13
    v_add_f32 v10, v10, v14
    v_add_f32 v11, v11, v15
    v_add_f32_dpp v8, v8, v8 row_ror:8 row_mask:0xf bank_mask:0x3
    v_add_f32_dpp v9, v9, v9 row_ror:8 row_mask:0xf bank_mask:0x3
    s_nop 0
    v_add_f32_dpp v8, v10, v10 row_ror:8 row_mask:0xf bank_mask:0xc
    v_add_f32_dpp v9, v11, v11 row_ror:8 row_mask:0xf bank_mask:0xc
    s_nop 0
    v_add_f32_dpp v8, v8, v8 row_half_mirror row_mask:0xf bank_mask:0x5
    s_nop 1
    v_add_f32_dpp v8, v9, v9 row_half_mirror row_mask:0xf bank_mask:0xa
    s_nop 1
    v_add_f32_dpp v8, v8, v8 quad_perm:[1,0,3,2] row_mask:0xf bank_mask:0xf
    s_nop 1
    v_add_f32_dpp v8, v8, v8 quad_perm:[2,3,0,1] row_mask:0xf bank_mask:0xf
    ds_write_b32 v3, v8 offset:0
    v_add_u32 v3, 32, v3
    s_sub_u32 s24, s24, 1
    s_cmp_lg_u32 s24, 0
    s_cbranch_scc1 L_kloop
    ds_read_b128 v[8:11], v61 offset:0
    ds_read_b32 v16, v60 offset:1024
    s_mov_b32 s83, 0x3db8aa3b
    s_waitcnt lgkmcnt(0)
    v_max3_f32 v12, v8, v9, v16
    v_max3_f32 v12, v10, v11, v12
    s_nop 1
    v_max_f32_dpp v12, v12, v12 quad_perm:[1,0,3,2] row_mask:0xf bank_mask:0xf
    s_nop 1
    v_max_f32_dpp v12, v12, v12 quad_perm:[2,3,0,1] row_mask:0xf bank_mask:0xf
    s_nop 1
    v_max_f32_dpp v12, v12, v12 row_half_mirror row_mask:0xf bank_mask:0xf
    s_nop 1
    v_max_f32_dpp v12, v12, v12 row_mirror row_mask:0xf bank_mask:0xf
    v_mov_b32 v13, v12
    s_nop 1
    v_permlane16_swap_b32 v12, v13
    v_max_f32 v12, v12, v13
    v_mov_b32 v13, v12
    s_nop 1
    v_permlane32_swap_b32 v12, v13
    v_max_f32 v12, v12, v13
    v_mul_f32 v63, s83, v12
    v_fma_f32 v8, v8, s83, -v63
    v_fma_f32 v9, v9, s83, -v63
    v_fma_f32 v10, v10, s83, -v63
    v_fma_f32 v11, v11, s83, -v63
    v_fma_f32 v16, v16, s83, -v63
    v_exp_f32 v8, v8
    v_exp_f32 v9, v9
    v_exp_f32 v10, v10
    v_exp_f32 v11, v11
    v_exp_f32 v16, v16
    v_cvt_pk_bf16_f32 v9, v8, v9
    v_cvt_pk_bf16_f32 v11, v10, v11
    v_cvt_pk_bf16_f32 v16, 0, v16
    v_lshlrev_b32 v8, 16, v9
    v_and_b32 v9, 0xffff0000, v9
    v_lshlrev_b32 v10, 16, v11
    v_and_b32 v11, 0xffff0000, v11
    ds_write_b128 v61, v[8:11] offset:0
    ds_write_b32 v60, v16 offset:1024
    v_add_f32 v14, v8, v9
    v_add_f32 v15, v10, v11
    v_add_f32 v14, v14, v16
    v_add_f32 v61, v14, v15
    s_nop 1
    v_add_f32_dpp v61, v61, v61 quad_perm:[1,0,3,2] row_mask:0xf bank_mask:0xf
    s_nop 1
    v_add_f32_dpp v61, v61, v61 quad_perm:[2,3,0,1] row_mask:0xf bank_mask:0xf
    s_nop 1
    v_add_f32_dpp v61, v61, v61 row_half_mirror row_mask:0xf bank_mask:0xf
    s_nop 1
    v_add_f32_dpp v61, v61, v61 row_mirror row_mask:0xf bank_mask:0xf
    v_mov_b32 v13, v61
    s_nop 1
    v_permlane16_swap_b32 v61, v13
    v_add_f32 v61, v61, v13
    v_mov_b32 v32, 0
    v_mov_b32 v33, 0
    v_mov_b32 v34, 0
    v_mov_b32 v35, 0
    v_mov_b32 v36, 0
    v_mov_b32 v37, 0
    v_mov_b32 v38, 0
    v_mov_b32 v39, 0
    s_add_u32 s16, s34, s85
    s_addc_u32 s17, s35, 0
    s_mov_b32 s18, 0x400000
    v_mov_b32 v22, 7936
    v_mov_b32 v29, 0
    s_mov_b32 s94, 1
    s_and_b32 s24, s31, 15
    s_lshl_b32 s24, s24, 4
    s_lshr_b32 s25, s31, 4
    s_lshl_b32 s25, s25, 3
    s_add_u32 s25, s25, s28
    s_add_u32 s24, s24, s25
    s_mul_i32 s24, s24, 640
    s_add_u32 s87, s24, 65536
    s_sub_u32 s88, s84, 1
L_vloop:
    s_cmp_lg_u32 s88, 1
    s_cbranch_scc1 L_vgo
    s_cmp_lg_u32 s3, 0
    s_cbranch_scc1 L_vgo
    v_mov_b32 v23, s94
    ds_write_b32 v29, v23 offset:7744
L_vgo:
    ds_read_b128 v[40:43], v62 offset:0
    ds_read_b128 v[44:47], v62 offset:16
    s_waitcnt lgkmcnt(1)
    v_lshrrev_b32 v8, 16, v40
    s_waitcnt vmcnt(7)
    v_dot2c_f32_bf16 v33, v64, v40
    v_dot2c_f32_bf16 v35, v65, v40
    v_dot2c_f32_bf16 v37, v66, v40
    v_dot2c_f32_bf16 v39, v67, v40
    v_dot2c_f32_bf16 v32, v64, v8
    v_dot2c_f32_bf16 v34, v65, v8
    v_dot2c_f32_bf16 v36, v66, v8
    v_dot2c_f32_bf16 v38, v67, v8
    buffer_load_dwordx4 v[64:67], v2, s[4:7], s22 offen nt
    s_addk_i32 s22, 0x1000
    v_lshrrev_b32 v8, 16, v41
    s_waitcnt vmcnt(7)
    v_dot2c_f32_bf16 v33, v68, v41
    v_dot2c_f32_bf16 v35, v69, v41
    v_dot2c_f32_bf16 v37, v70, v41
    v_dot2c_f32_bf16 v39, v71, v41
    v_dot2c_f32_bf16 v32, v68, v8
    v_dot2c_f32_bf16 v34, v69, v8
    v_dot2c_f32_bf16 v36, v70, v8
    v_dot2c_f32_bf16 v38, v71, v8
    buffer_load_dwordx4 v[68:71], v2, s[4:7], s22 offen nt
    s_addk_i32 s22, 0x1000
    v_lshrrev_b32 v8, 16, v42
    s_waitcnt vmcnt(7)
    v_dot2c_f32_bf16 v33, v72, v42
    v_dot2c_f32_bf16 v35, v73, v42
    v_dot2c_f32_bf16 v37, v74, v42
    v_dot2c_f32_bf16 v39, v75, v42
    v_dot2c_f32_bf16 v32, v72, v8
    v_dot2c_f32_bf16 v34, v73, v8
    v_dot2c_f32_bf16 v36, v74, v8
    v_dot2c_f32_bf16 v38, v75, v8
    buffer_load_dwordx4 v[72:75], v2, s[4:7], s22 offen nt
    s_addk_i32 s22, 0x1000
    v_lshrrev_b32 v8, 16, v43
    s_waitcnt vmcnt(7)
    v_dot2c_f32_bf16 v33, v76, v43
    v_dot2c_f32_bf16 v35, v77, v43
    v_dot2c_f32_bf16 v37, v78, v43
    v_dot2c_f32_bf16 v39, v79, v43
    v_dot2c_f32_bf16 v32, v76, v8
    v_dot2c_f32_bf16 v34, v77, v8
    v_dot2c_f32_bf16 v36, v78, v8
    v_dot2c_f32_bf16 v38, v79, v8
    buffer_load_dwordx4 v[76:79], v2, s[4:7], s22 offen nt
    s_addk_i32 s22, 0x1000
    s_waitcnt lgkmcnt(0)
    v_lshrrev_b32 v8, 16, v44
    s_waitcnt vmcnt(7)
    v_dot2c_f32_bf16 v33, v80, v44
    v_dot2c_f32_bf16 v35, v81, v44
    v_dot2c_f32_bf16 v37, v82, v44
    v_dot2c_f32_bf16 v39, v83, v44
    v_dot2c_f32_bf16 v32, v80, v8
    v_dot2c_f32_bf16 v34, v81, v8
    v_dot2c_f32_bf16 v36, v82, v8
    v_dot2c_f32_bf16 v38, v83, v8
    buffer_load_dwordx4 v[80:83], v2, s[4:7], s22 offen nt
    s_addk_i32 s22, 0x1000
    v_lshrrev_b32 v8, 16, v45
    s_waitcnt vmcnt(7)
    v_dot2c_f32_bf16 v33, v84, v45
    v_dot2c_f32_bf16 v35, v85, v45
    v_dot2c_f32_bf16 v37, v86, v45
    v_dot2c_f32_bf16 v39, v87, v45
    v_dot2c_f32_bf16 v32, v84, v8
    v_dot2c_f32_bf16 v34, v85, v8
    v_dot2c_f32_bf16 v36, v86, v8
    v_dot2c_f32_bf16 v38, v87, v8
    buffer_load_dwordx4 v[84:87], v2, s[4:7], s22 offen nt
    s_addk_i32 s22, 0x1000
    v_lshrrev_b32 v8, 16, v46
    s_waitcnt vmcnt(7)
    v_dot2c_f32_bf16 v33, v88, v46
    v_dot2c_f32_bf16 v35, v89, v46
    v_dot2c_f32_bf16 v37, v90, v46
    v_dot2c_f32_bf16 v39, v91, v46
    v_dot2c_f32_bf16 v32, v88, v8
    v_dot2c_f32_bf16 v34, v89, v8
    v_dot2c_f32_bf16 v36, v90, v8
    v_dot2c_f32_bf16 v38, v91, v8
    buffer_load_dwordx4 v[88:91], v2, s[4:7], s22 offen nt
    s_addk_i32 s22, 0x1000
    v_lshrrev_b32 v8, 16, v47
    s_waitcnt vmcnt(7)
    v_dot2c_f32_bf16 v33, v92, v47
    v_dot2c_f32_bf16 v35, v93, v47
    v_dot2c_f32_bf16 v37, v94, v47
    v_dot2c_f32_bf16 v39, v95, v47
    v_dot2c_f32_bf16 v32, v92, v8
    v_dot2c_f32_bf16 v34, v93, v8
    v_dot2c_f32_bf16 v36, v94, v8
    v_dot2c_f32_bf16 v38, v95, v8
    buffer_load_dwordx4 v[92:95], v2, s[4:7], s22 offen nt
    s_addk_i32 s22, 0x1000
    v_add_u32 v62, 32, v62
    s_sub_u32 s88, s88, 1
    s_cmp_lg_u32 s88, 0
    s_cbranch_scc1 L_vloop
L_n0:
    ds_read_b32 v23, v22
    s_waitcnt lgkmcnt(0)
    v_readfirstlane_b32 s24, v23
    s_cmp_eq_u32 s24, 0
    s_cbranch_scc1 L_n0
    s_add_u32 s94, s94, 1
    v_add_u32 v22, 4, v22
    s_cmp_lg_u32 s3, 0
    s_cbranch_scc1 L_n0b
    v_mov_b32 v23, s94
    ds_write_b32 v29, v23 offset:7744
L_n0b:
    s_add_u32 s25, s24, 223
    s_lshl_b32 s22, s25, 14
    s_cmp_gt_u32 s24, 32
    s_cselect_b32 s95, 1, 0
    s_cselect_b32 s6, 0, s6
    s_cselect_b32 s18, 0, s18
    s_cselect_b32 s22, 0, s22
    ds_read_b128 v[40:43], v62 offset:0
    ds_read_b128 v[44:47], v62 offset:16
    s_waitcnt lgkmcnt(1)
    v_lshrrev_b32 v8, 16, v40
    s_waitcnt vmcnt(7)
    v_dot2c_f32_bf16 v33, v64, v40
    v_dot2c_f32_bf16 v35, v65, v40
    v_dot2c_f32_bf16 v37, v66, v40
    v_dot2c_f32_bf16 v39, v67, v40
    v_dot2c_f32_bf16 v32, v64, v8
    v_dot2c_f32_bf16 v34, v65, v8
    v_dot2c_f32_bf16 v36, v66, v8
    v_dot2c_f32_bf16 v38, v67, v8
    buffer_load_dwordx4 v[64:67], v2, s[16:19], s22 offen nt
    s_addk_i32 s22, 0x1000
    v_lshrrev_b32 v8, 16, v41
    s_waitcnt vmcnt(7)
    v_dot2c_f32_bf16 v33, v68, v41
    v_dot2c_f32_bf16 v35, v69, v41
    v_dot2c_f32_bf16 v37, v70, v41
    v_dot2c_f32_bf16 v39, v71, v41
    v_dot2c_f32_bf16 v32, v68, v8
    v_dot2c_f32_bf16 v34, v69, v8
    v_dot2c_f32_bf16 v36, v70, v8
    v_dot2c_f32_bf16 v38, v71, v8
    buffer_load_dwordx4 v[68:71], v2, s[16:19], s22 offen nt
    s_addk_i32 s22, 0x1000
    v_lshrrev_b32 v8, 16, v42
    s_waitcnt vmcnt(7)
    v_dot2c_f32_bf16 v33, v72, v42
    v_dot2c_f32_bf16 v35, v73, v42
    v_dot2c_f32_bf16 v37, v74, v42
    v_dot2c_f32_bf16 v39, v75, v42
    v_dot2c_f32_bf16 v32, v72, v8
    v_dot2c_f32_bf16 v34, v73, v8
    v_dot2c_f32_bf16 v36, v74, v8
    v_dot2c_f32_bf16 v38, v75, v8
    buffer_load_dwordx4 v[72:75], v2, s[16:19], s22 offen nt
    s_addk_i32 s22, 0x1000
    v_lshrrev_b32 v8, 16, v43
    s_waitcnt vmcnt(7)
    v_dot2c_f32_bf16 v33, v76, v43
    v_dot2c_f32_bf16 v35, v77, v43
    v_dot2c_f32_bf16 v37, v78, v43
    v_dot2c_f32_bf16 v39, v79, v43
    v_dot2c_f32_bf16 v32, v76, v8
    v_dot2c_f32_bf16 v34, v77, v8
    v_dot2c_f32_bf16 v36, v78, v8
    v_dot2c_f32_bf16 v38, v79, v8
    buffer_load_dwordx4 v[76:79], v2, s[16:19], s22 offen nt
    s_addk_i32 s22, 0xd000
    s_waitcnt lgkmcnt(0)
    v_lshrrev_b32 v8, 16, v44
    s_waitcnt vmcnt(7)
    v_dot2c_f32_bf16 v33, v80, v44
    v_dot2c_f32_bf16 v35, v81, v44
    v_dot2c_f32_bf16 v37, v82, v44
    v_dot2c_f32_bf16 v39, v83, v44
    v_dot2c_f32_bf16 v32, v80, v8
    v_dot2c_f32_bf16 v34, v81, v8
    v_dot2c_f32_bf16 v36, v82, v8
    v_dot2c_f32_bf16 v38, v83, v8
    buffer_load_dwordx4 v[80:83], v2, s[4:7], s22 offen nt
    s_addk_i32 s22, 0x1000
    v_lshrrev_b32 v8, 16, v45
    s_waitcnt vmcnt(7)
    v_dot2c_f32_bf16 v33, v84, v45
    v_dot2c_f32_bf16 v35, v85, v45
    v_dot2c_f32_bf16 v37, v86, v45
    v_dot2c_f32_bf16 v39, v87, v45
    v_dot2c_f32_bf16 v32, v84, v8
    v_dot2c_f32_bf16 v34, v85, v8
    v_dot2c_f32_bf16 v36, v86, v8
    v_dot2c_f32_bf16 v38, v87, v8
    buffer_load_dwordx4 v[84:87], v2, s[4:7], s22 offen nt
    s_addk_i32 s22, 0x1000
    v_lshrrev_b32 v8, 16, v46
    s_waitcnt vmcnt(7)
    v_dot2c_f32_bf16 v33, v88, v46
    v_dot2c_f32_bf16 v35, v89, v46
    v_dot2c_f32_bf16 v37, v90, v46
    v_dot2c_f32_bf16 v39, v91, v46
    v_dot2c_f32_bf16 v32, v88, v8
    v_dot2c_f32_bf16 v34, v89, v8
    v_dot2c_f32_bf16 v36, v90, v8
    v_dot2c_f32_bf16 v38, v91, v8
    buffer_load_dwordx4 v[88:91], v2, s[4:7], s22 offen nt
    s_addk_i32 s22, 0x1000
    v_lshrrev_b32 v8, 16, v47
    s_waitcnt vmcnt(7)
    v_dot2c_f32_bf16 v33, v92, v47
    v_dot2c_f32_bf16 v35, v93, v47
    v_dot2c_f32_bf16 v37, v94, v47
    v_dot2c_f32_bf16 v39, v95, v47
    v_dot2c_f32_bf16 v32, v92, v8
    v_dot2c_f32_bf16 v34, v93, v8
    v_dot2c_f32_bf16 v36, v94, v8
    v_dot2c_f32_bf16 v38, v95, v8
    buffer_load_dwordx4 v[92:95], v2, s[4:7], s22 offen nt
    s_addk_i32 s22, 0x1000
    s_cmp_lg_u32 s95, 0
    s_cbranch_scc1 L_fin
L_pool:
L_n1:
    ds_read_b32 v23, v22
    s_waitcnt lgkmcnt(0)
    v_readfirstlane_b32 s24, v23
    s_cmp_eq_u32 s24, 0
    s_cbranch_scc1 L_n1
    s_add_u32 s94, s94, 1
    v_add_u32 v22, 4, v22
    s_cmp_lg_u32 s3, 0
    s_cbranch_scc1 L_n1b
    v_mov_b32 v23, s94
    ds_write_b32 v29, v23 offset:7744
L_n1b:
    s_add_u32 s25, s24, 223
    s_lshl_b32 s22, s25, 14
    s_cmp_gt_u32 s24, 32
    s_cselect_b32 s95, 1, 0
    s_cselect_b32 s6, 0, s6
    s_cselect_b32 s18, 0, s18
    s_cselect_b32 s22, 0, s22
    s_waitcnt vmcnt(7)
    v_dot2_f32_bf16 v8, v64, v4, 0
    v_dot2_f32_bf16 v8, v65, v5, v8
    v_dot2_f32_bf16 v8, v66, v6, v8
    v_dot2_f32_bf16 v8, v67, v7, v8
    buffer_load_dwordx4 v[64:67], v2, s[16:19], s22 offen nt
    s_addk_i32 s22, 0x1000
    s_waitcnt vmcnt(7)
    v_dot2_f32_bf16 v9, v68, v4, 0
    v_dot2_f32_bf16 v9, v69, v5, v9
    v_dot2_f32_bf16 v9, v70, v6, v9
    v_dot2_f32_bf16 v9, v71, v7, v9
    buffer_load_dwordx4 v[68:71], v2, s[16:19], s22 offen nt
    s_addk_i32 s22, 0x1000
    s_waitcnt vmcnt(7)
    v_dot2_f32_bf16 v10, v72, v4, 0
    v_dot2_f32_bf16 v10, v73, v5, v10
    v_dot2_f32_bf16 v10, v74, v6, v10
    v_dot2_f32_bf16 v10, v75, v7, v10
    buffer_load_dwordx4 v[72:75], v2, s[16:19], s22 offen nt
    s_addk_i32 s22, 0x1000
    s_waitcnt vmcnt(7)
    v_dot2_f32_bf16 v11, v76, v4, 0
    v_dot2_f32_bf16 v11, v77, v5, v11
    v_dot2_f32_bf16 v11, v78, v6, v11
    v_dot2_f32_bf16 v11, v79, v7, v11
    buffer_load_dwordx4 v[76:79], v2, s[16:19], s22 offen nt
    s_addk_i32 s22, 0xd000
    v_permlane16_swap_b32 v8, v10
    v_permlane16_swap_b32 v9, v11
    v_add_f32 v8, v8, v10
    v_add_f32 v9, v9, v11
    s_nop 0
    v_add_f32_dpp v8, v8, v8 row_ror:8 row_mask:0xf bank_mask:0x3
    s_nop 1
    v_add_f32_dpp v8, v9, v9 row_ror:8 row_mask:0xf bank_mask:0xc
    s_nop 1
    v_add_f32_dpp v8, v8, v8 row_half_mirror row_mask:0xf bank_mask:0xf
    s_nop 1
    v_add_f32_dpp v8, v8, v8 quad_perm:[1,0,3,2] row_mask:0xf bank_mask:0xf
    s_nop 1
    v_add_f32_dpp v8, v8, v8 quad_perm:[2,3,0,1] row_mask:0xf bank_mask:0xf
    v_mul_f32 v8, s83, v8
    v_cmp_gt_f32 vcc, v8, v63
    s_cbranch_vccz L_nomax
    v_max_f32_dpp v9, v8, v8 row_ror:8 row_mask:0xf bank_mask:0xf
    v_mov_b32 v10, v9
    s_nop 1
    v_permlane16_swap_b32 v9, v10
    v_max_f32 v9, v9, v10
    v_mov_b32 v10, v9
    s_nop 1
    v_permlane32_swap_b32 v9, v10
    v_max_f32 v9, v9, v10
    v_sub_f32 v10, v63, v9
    v_exp_f32 v10, v10
    v_mov_b32 v63, v9
    v_mul_f32 v61, v61, v10
    v_mul_f32 v32, v32, v10
    v_mul_f32 v33, v33, v10
    v_mul_f32 v34, v34, v10
    v_mul_f32 v35, v35, v10
    v_mul_f32 v36, v36, v10
    v_mul_f32 v37, v37, v10
    v_mul_f32 v38, v38, v10
    v_mul_f32 v39, v39, v10
L_nomax:
    v_sub_f32 v8, v8, v63
    v_exp_f32 v8, v8
    s_nop 0
    v_cvt_pk_bf16_f32 v8, 0, v8
    s_nop 1
    v_mov_b32_dpp v40, v8 row_newbcast:0 row_mask:0xf bank_mask:0xf
    v_mov_b32_dpp v41, v8 row_newbcast:8 row_mask:0xf bank_mask:0xf
    v_mov_b32 v42, v40
    v_mov_b32 v43, v41
    s_nop 0
    v_permlane16_swap_b32 v40, v42
    v_permlane16_swap_b32 v41, v43
    v_add_f32 v9, v40, v41
    v_add_f32 v10, v42, v43
    v_add_f32 v61, v61, v9
    v_add_f32 v61, v61, v10
    v_lshrrev_b32 v8, 16, v40
    s_waitcnt vmcnt(7)
    v_dot2c_f32_bf16 v33, v80, v40
    v_dot2c_f32_bf16 v35, v81, v40
    v_dot2c_f32_bf16 v37, v82, v40
    v_dot2c_f32_bf16 v39, v83, v40
    v_dot2c_f32_bf16 v32, v80, v8
    v_dot2c_f32_bf16 v34, v81, v8
    v_dot2c_f32_bf16 v36, v82, v8
    v_dot2c_f32_bf16 v38, v83, v8
    buffer_load_dwordx4 v[80:83], v2, s[4:7], s22 offen nt
    s_addk_i32 s22, 0x1000
    v_lshrrev_b32 v8, 16, v41
    s_waitcnt vmcnt(7)
    v_dot2c_f32_bf16 v33, v84, v41
    v_dot2c_f32_bf16 v35, v85, v41
    v_dot2c_f32_bf16 v37, v86, v41
    v_dot2c_f32_bf16 v39, v87, v41
    v_dot2c_f32_bf16 v32, v84, v8
    v_dot2c_f32_bf16 v34, v85, v8
    v_dot2c_f32_bf16 v36, v86, v8
    v_dot2c_f32_bf16 v38, v87, v8
    buffer_load_dwordx4 v[84:87], v2, s[4:7], s22 offen nt
    s_addk_i32 s22, 0x1000
    v_lshrrev_b32 v8, 16, v42
    s_waitcnt vmcnt(7)
    v_dot2c_f32_bf16 v33, v88, v42
    v_dot2c_f32_bf16 v35, v89, v42
    v_dot2c_f32_bf16 v37, v90, v42
    v_dot2c_f32_bf16 v39, v91, v42
    v_dot2c_f32_bf16 v32, v88, v8
    v_dot2c_f32_bf16 v34, v89, v8
    v_dot2c_f32_bf16 v36, v90, v8
    v_dot2c_f32_bf16 v38, v91, v8
    buffer_load_dwordx4 v[88:91], v2, s[4:7], s22 offen nt
    s_addk_i32 s22, 0x1000
    v_lshrrev_b32 v8, 16, v43
    s_waitcnt vmcnt(7)
    v_dot2c_f32_bf16 v33, v92, v43
    v_dot2c_f32_bf16 v35, v93, v43
    v_dot2c_f32_bf16 v37, v94, v43
    v_dot2c_f32_bf16 v39, v95, v43
    v_dot2c_f32_bf16 v32, v92, v8
    v_dot2c_f32_bf16 v34, v93, v8
    v_dot2c_f32_bf16 v36, v94, v8
    v_dot2c_f32_bf16 v38, v95, v8
    buffer_load_dwordx4 v[92:95], v2, s[4:7], s22 offen nt
    s_addk_i32 s22, 0x1000
    s_cmp_eq_u32 s95, 0
    s_cbranch_scc1 L_pool
L_fin:
    v_mov_b32 v60, v61
    s_lshl_b32 s24, s3, 3
    v_mov_b32 v23, s24
    v_mov_b32 v51, 1
    v_lshlrev_b32 v52, 4, v1
    v_permlane32_swap_b32 v32, v36
    v_permlane32_swap_b32 v33, v37
    v_permlane32_swap_b32 v34, v38
    v_permlane32_swap_b32 v35, v39
    v_permlane32_swap_b32 v60, v61
    v_add_f32 v32, v32, v36
    v_add_f32 v33, v33, v37
    v_add_f32 v34, v34, v38
    v_add_f32 v35, v35, v39
    v_add_f32 v62, v60, v61
    ds_write_b128 v2, v[32:35] offset:8192
    ds_write_b64 v23, v[62:63] offset:7680
    s_mov_b64 exec, 1
    ds_add_rtn_u32 v50, v29, v51 offset:7752
    s_mov_b64 exec, -1
    ds_read_b128 v[40:43], v29 offset:7680
    ds_read_b128 v[44:47], v29 offset:7696
    ds_read_b128 v[8:11], v52 offset:8192
    ds_read_b128 v[12:15], v52 offset:9216
    ds_read_b128 v[16:19], v52 offset:10240
    ds_read_b128 v[20:23], v52 offset:11264
    s_waitcnt lgkmcnt(4)
    v_readfirstlane_b32 s24, v50
    v_max3_f32 v49, v41, v43, v45
    v_max_f32 v49, v49, v47
    s_cmp_lt_u32 s24, 3
    s_cbranch_scc1 L_opub_done
    v_sub_f32 v41, v41, v49
    v_sub_f32 v43, v43, v49
    v_sub_f32 v45, v45, v49
    v_sub_f32 v47, v47, v49
    v_exp_f32 v41, v41
    v_exp_f32 v43, v43
    v_exp_f32 v45, v45
    v_exp_f32 v47, v47
    s_waitcnt lgkmcnt(3)
    v_mul_f32 v32, v8, v41
    v_mul_f32 v33, v9, v41
    v_mul_f32 v34, v10, v41
    v_mul_f32 v35, v11, v41
    v_mul_f32 v48, v40, v41
    s_waitcnt lgkmcnt(2)
    v_fmac_f32 v32, v12, v43
    v_fmac_f32 v33, v13, v43
    v_fmac_f32 v34, v14, v43
    v_fmac_f32 v35, v15, v43
    s_waitcnt lgkmcnt(1)
    v_fmac_f32 v32, v16, v45
    v_fmac_f32 v33, v17, v45
    v_fmac_f32 v34, v18, v45
    v_fmac_f32 v35, v19, v45
    s_waitcnt lgkmcnt(0)
    v_fmac_f32 v32, v20, v47
    v_fmac_f32 v33, v21, v47
    v_fmac_f32 v34, v22, v47
    v_fmac_f32 v35, v23, v47
    v_cvt_pk_bf16_f32 v8, v32, v33
    v_cvt_pk_bf16_f32 v9, v34, v35
    v_fmac_f32 v48, v42, v43
    v_min_u32 v8, -2, v8
    v_min_u32 v9, -2, v9
    v_fmac_f32 v48, v44, v45
    v_fmac_f32 v48, v46, v47
    v_permlane32_swap_b32 v8, v10
    v_permlane32_swap_b32 v9, v11
    s_mov_b32 exec_hi, 0
    buffer_store_dwordx4 v[8:11], v52, s[8:11], s87 offen sc1
    s_mov_b64 exec, 1
    buffer_store_dwordx2 v[48:49], v52, s[8:11], s87 offen offset:512 sc1
    s_mov_b64 exec, -1
L_opub_done:
    s_cmp_lg_u32 s57, 1
    s_cbranch_scc1 L_exit
    s_waitcnt lgkmcnt(0)
    s_barrier
    v_mov_b32 v57, 1
    v_lshlrev_b32 v58, 4, v1
    ds_read_b32 v12, v29 offset:7748
    v_and_b32 v16, 15, v1
    v_lshrrev_b32 v18, 4, v1
    v_mul_u32_u24 v5, 640, v16
    v_lshl_add_u32 v4, v18, 4, v5
    s_lshl_b32 s24, s58, 2
    s_add_u32 s24, s24, s3
    s_mul_i32 s24, s24, 10240
    s_add_u32 s24, s24, 65536
    s_lshl_b32 s30, s31, 2
    s_add_u32 s30, s30, s3
    s_lshl_b32 s27, s30, 5
    s_add_u32 s27, s27, 262144
    s_lshl_b32 s30, s30, 3
    v_and_b32 v19, 31, v1
    v_mul_u32_u24 v0, 3584, v19
    v_lshrrev_b32 v17, 5, v1
    v_lshl_add_u32 v0, v17, 4, v0
    v_mov_b32 v20, 0x7fff0000
    v_cmp_gt_u32 vcc, 28, v19
    s_nop 1
    v_cndmask_b32 v0, v20, v0, vcc
    v_lshlrev_b32 v3, 8, v17
    v_and_b32 v19, 1, v18
    v_lshl_add_u32 v3, v19, 6, v3
    v_lshl_add_u32 v3, v16, 2, v3
    s_lshl_b32 s25, s3, 9
    v_add_u32 v3, s25, v3
    v_mul_u32_u24 v6, 1792, v19
    v_lshl_add_u32 v6, v16, 4, v6
    s_mul_i32 s26, s58, 3584
    s_lshl_b32 s25, s59, 8
    s_add_u32 s26, s26, s25
    s_add_u32 s26, s26, 229376
    buffer_load_dwordx4 v[52:55], v0, s[8:11], s27 offen sc1
    s_waitcnt lgkmcnt(0)
    v_readfirstlane_b32 s92, v12
    s_mov_b32 s61, 200000
L_opoll:
    buffer_load_dwordx2 v[40:41], v5, s[8:11], s24 offen offset:512 sc1
    buffer_load_dwordx4 v[64:67], v4, s[8:11], s24 offen offset:0 sc1
    buffer_load_dwordx4 v[68:71], v4, s[8:11], s24 offen offset:64 sc1
    buffer_load_dwordx4 v[72:75], v4, s[8:11], s24 offen offset:128 sc1
    buffer_load_dwordx4 v[76:79], v4, s[8:11], s24 offen offset:192 sc1
    buffer_load_dwordx4 v[80:83], v4, s[8:11], s24 offen offset:256 sc1
    buffer_load_dwordx4 v[84:87], v4, s[8:11], s24 offen offset:320 sc1
    buffer_load_dwordx4 v[88:91], v4, s[8:11], s24 offen offset:384 sc1
    buffer_load_dwordx4 v[92:95], v4, s[8:11], s24 offen offset:448 sc1
    s_sub_u32 s61, s61, 1
    s_cmp_eq_u32 s61, 0
    s_cbranch_scc1 L_oto
    s_waitcnt vmcnt(6)
    v_max3_u32 v8, v40, v41, v64
    v_max3_u32 v9, v65, v66, v67
    v_max3_u32 v8, v68, v69, v8
    v_max3_u32 v9, v70, v71, v9
    s_waitcnt vmcnt(4)
    v_max3_u32 v8, v72, v73, v8
    v_max3_u32 v9, v74, v75, v9
    v_max3_u32 v8, v76, v77, v8
    v_max3_u32 v9, v78, v79, v9
    s_waitcnt vmcnt(2)
    v_max3_u32 v8, v80, v81, v8
    v_max3_u32 v9, v82, v83, v9
    v_max3_u32 v8, v84, v85, v8
    v_max3_u32 v9, v86, v87, v9
    s_waitcnt vmcnt(0)
    v_max3_u32 v8, v88, v89, v8
    v_max3_u32 v9, v90, v91, v9
    v_max3_u32 v8, v92, v93, v8
    v_max3_u32 v9, v94, v95, v9
    v_max_u32 v8, v8, v9
    v_cmp_eq_u32 vcc, -1, v8
    s_mov_b64 exec, vcc
    s_cbranch_execnz L_opoll
L_oto:
    s_mov_b64 exec, -1
    v_mfma_f32_16x16x32_bf16 v[8:11], v[64:67], v[128:131], 0
    v_max_f32_dpp v42, v41, v41 quad_perm:[1,0,3,2] row_mask:0xf bank_mask:0xf
    v_mfma_f32_16x16x32_bf16 v[12:15], v[64:67], v[132:135], 0
    s_nop 0
    v_max_f32_dpp v42, v42, v42 quad_perm:[2,3,0,1] row_mask:0xf bank_mask:0xf
    v_mfma_f32_16x16x32_bf16 v[16:19], v[64:67], v[136:139], 0
    s_nop 0
    v_max_f32_dpp v42, v42, v42 row_half_mirror row_mask:0xf bank_mask:0xf
    v_mfma_f32_16x16x32_bf16 v[20:23], v[64:67], v[140:143], 0
    v_sub_f32 v43, v41, v42
    v_mfma_f32_16x16x32_bf16 v[8:11], v[68:71], v[144:147], v[8:11]
    v_exp_f32 v43, v43
    v_mfma_f32_16x16x32_bf16 v[12:15], v[68:71], v[148:151], v[12:15]
    v_mul_f32 v44, v43, v40
    v_mfma_f32_16x16x32_bf16 v[16:19], v[68:71], v[152:155], v[16:19]
    s_nop 0
    v_add_f32_dpp v44, v44, v44 quad_perm:[1,0,3,2] row_mask:0xf bank_mask:0xf
    v_mfma_f32_16x16x32_bf16 v[20:23], v[68:71], v[156:159], v[20:23]
    s_nop 0
    v_add_f32_dpp v44, v44, v44 quad_perm:[2,3,0,1] row_mask:0xf bank_mask:0xf
    v_mfma_f32_16x16x32_bf16 v[8:11], v[72:75], v[160:163], v[8:11]
    s_nop 0
    v_add_f32_dpp v44, v44, v44 row_half_mirror row_mask:0xf bank_mask:0xf
    v_mfma_f32_16x16x32_bf16 v[12:15], v[72:75], v[164:167], v[12:15]
    v_rcp_f32 v44, v44
    v_mfma_f32_16x16x32_bf16 v[16:19], v[72:75], v[168:171], v[16:19]
    v_mul_f32 v45, v43, v44
    v_mfma_f32_16x16x32_bf16 v[20:23], v[72:75], v[172:175], v[20:23]
    s_nop 0
    v_mov_b32_dpp v48, v45 row_newbcast:0 row_mask:0x1 bank_mask:0xf
    v_mfma_f32_16x16x32_bf16 v[8:11], v[76:79], v[176:179], v[8:11]
    v_mov_b32_dpp v49, v45 row_newbcast:1 row_mask:0x1 bank_mask:0xf
    v_mfma_f32_16x16x32_bf16 v[12:15], v[76:79], v[180:183], v[12:15]
    v_mov_b32_dpp v50, v45 row_newbcast:2 row_mask:0x1 bank_mask:0xf
    v_mfma_f32_16x16x32_bf16 v[16:19], v[76:79], v[184:187], v[16:19]
    v_mov_b32_dpp v51, v45 row_newbcast:3 row_mask:0x1 bank_mask:0xf
    v_mfma_f32_16x16x32_bf16 v[20:23], v[76:79], v[188:191], v[20:23]
    v_mov_b32_dpp v48, v45 row_newbcast:4 row_mask:0x2 bank_mask:0xf
    v_mfma_f32_16x16x32_bf16 v[8:11], v[80:83], v[192:195], v[8:11]
    v_mov_b32_dpp v49, v45 row_newbcast:5 row_mask:0x2 bank_mask:0xf
    v_mfma_f32_16x16x32_bf16 v[12:15], v[80:83], v[196:199], v[12:15]
    v_mov_b32_dpp v50, v45 row_newbcast:6 row_mask:0x2 bank_mask:0xf
    v_mfma_f32_16x16x32_bf16 v[16:19], v[80:83], v[200:203], v[16:19]
    v_mov_b32_dpp v51, v45 row_newbcast:7 row_mask:0x2 bank_mask:0xf
    v_mfma_f32_16x16x32_bf16 v[20:23], v[80:83], v[204:207], v[20:23]
    v_mov_b32_dpp v48, v45 row_newbcast:8 row_mask:0x4 bank_mask:0xf
    v_mfma_f32_16x16x32_bf16 v[8:11], v[84:87], v[208:211], v[8:11]
    v_mov_b32_dpp v49, v45 row_newbcast:9 row_mask:0x4 bank_mask:0xf
    v_mfma_f32_16x16x32_bf16 v[12:15], v[84:87], v[212:215], v[12:15]
    v_mov_b32_dpp v50, v45 row_newbcast:10 row_mask:0x4 bank_mask:0xf
    v_mfma_f32_16x16x32_bf16 v[16:19], v[84:87], v[216:219], v[16:19]
    v_mov_b32_dpp v51, v45 row_newbcast:11 row_mask:0x4 bank_mask:0xf
    v_mfma_f32_16x16x32_bf16 v[20:23], v[84:87], v[220:223], v[20:23]
    v_mov_b32_dpp v48, v45 row_newbcast:12 row_mask:0x8 bank_mask:0xf
    v_mfma_f32_16x16x32_bf16 v[8:11], v[88:91], v[224:227], v[8:11]
    v_mov_b32_dpp v49, v45 row_newbcast:13 row_mask:0x8 bank_mask:0xf
    v_mfma_f32_16x16x32_bf16 v[12:15], v[88:91], v[228:231], v[12:15]
    v_mov_b32_dpp v50, v45 row_newbcast:14 row_mask:0x8 bank_mask:0xf
    v_mfma_f32_16x16x32_bf16 v[16:19], v[88:91], v[232:235], v[16:19]
    v_mov_b32_dpp v51, v45 row_newbcast:15 row_mask:0x8 bank_mask:0xf
    v_mfma_f32_16x16x32_bf16 v[20:23], v[88:91], v[236:239], v[20:23]
    v_mfma_f32_16x16x32_bf16 v[8:11], v[92:95], v[240:243], v[8:11]
    v_mfma_f32_16x16x32_bf16 v[12:15], v[92:95], v[244:247], v[12:15]
    v_mfma_f32_16x16x32_bf16 v[16:19], v[92:95], v[248:251], v[16:19]
    v_mfma_f32_16x16x32_bf16 v[20:23], v[92:95], v[252:255], v[20:23]
    s_nop 4
    v_mul_f32 v24, v8, v48
    v_mul_f32 v25, v12, v48
    v_fmac_f32 v24, v9, v49
    v_fmac_f32 v25, v13, v49
    v_mul_f32 v26, v16, v48
    v_fmac_f32 v24, v10, v50
    v_fmac_f32 v25, v14, v50
    v_fmac_f32 v26, v17, v49
    v_mul_f32 v27, v20, v48
    v_fmac_f32 v24, v11, v51
    v_fmac_f32 v25, v15, v51
    v_fmac_f32 v26, v18, v50
    v_fmac_f32 v27, v21, v49
    v_fmac_f32 v26, v19, v51
    v_fmac_f32 v27, v22, v50
    v_fmac_f32 v27, v23, v51
    v_permlane16_swap_b32 v24, v25
    s_nop 0
    v_permlane16_swap_b32 v26, v27
    v_add_f32 v24, v24, v25
    v_add_f32 v26, v26, v27
    ds_write_b32 v3, v24 offset:12288
    ds_write_b32 v3, v26 offset:12416
    s_mov_b64 exec, 1
    ds_add_rtn_u32 v56, v29, v57 offset:7756
    s_mov_b64 exec, -1
    ds_read_b128 v[8:11], v58 offset:12288
    ds_read_b128 v[12:15], v58 offset:12800
    ds_read_b128 v[16:19], v58 offset:13312
    ds_read_b128 v[20:23], v58 offset:13824
    v_lshrrev_b32 v4, 4, v1
    v_lshlrev_b32 v4, 3, v4
    v_bfe_u32 v30, v1, 2, 2
    v_add_u32 v4, v4, v30
    v_lshlrev_b32 v4, 7, v4
    v_and_b32 v30, 3, v1
    v_lshl_add_u32 v4, v30, 3, v4
    v_bfe_u32 v5, v1, 3, 2
    v_xor_b32 v5, s3, v5
    v_lshl_add_u32 v4, v5, 5, v4
    v_add_u32 v4, 16384, v4
    v_add_u32 v5, 57344, v4
    s_waitcnt lgkmcnt(2)
    v_readfirstlane_b32 s25, v56
    s_cmp_lt_u32 s25, 3
    s_cbranch_scc1 L_t1
    v_add_f32 v8, v8, v12
    v_add_f32 v9, v9, v13
    v_add_f32 v10, v10, v14
    v_add_f32 v11, v11, v15
    s_waitcnt lgkmcnt(0)
    v_add_f32 v16, v16, v20
    v_add_f32 v17, v17, v21
    v_add_f32 v18, v18, v22
    v_add_f32 v19, v19, v23
    v_add_f32 v8, v8, v16
    v_add_f32 v9, v9, v17
    v_add_f32 v10, v10, v18
    v_add_f32 v11, v11, v19
    s_mov_b32 exec_hi, 0
    s_cmp_eq_u32 s92, 1
    s_cbranch_scc1 L_pya
    buffer_store_dwordx4 v[8:11], v6, s[8:11], s26 offen sc1
    s_branch L_pyb
L_pya:
    buffer_store_dwordx4 v[8:11], v6, s[8:11], s26 offen
L_pyb:
    s_mov_b64 exec, -1
L_t1:
    s_barrier
    v_lshrrev_b32 v7, 4, v1
    v_lshlrev_b32 v7, 3, v7
    v_bfe_u32 v30, v1, 2, 2
    v_add_u32 v7, v7, v30
    v_mul_u32_u24 v7, 896, v7
    v_and_b32 v30, 3, v1
    v_lshl_add_u32 v7, v30, 3, v7
    s_mul_i32 s25, s3, 224
    s_add_u32 s25, s25, 131072
    v_add_u32 v7, s25, v7
    ds_read_b64_tr_b16 v[128:129], v4 offset:0
    ds_read_b64_tr_b16 v[184:185], v5 offset:0
    ds_read_b64_tr_b16 v[130:131], v4 offset:512
    ds_read_b64_tr_b16 v[186:187], v5 offset:512
    ds_read_b64_tr_b16 v[132:133], v4 offset:4096
    ds_read_b64_tr_b16 v[188:189], v5 offset:4096
    ds_read_b64_tr_b16 v[134:135], v4 offset:4608
    ds_read_b64_tr_b16 v[190:191], v5 offset:4608
    ds_read_b64_tr_b16 v[136:137], v4 offset:8192
    ds_read_b64_tr_b16 v[192:193], v5 offset:8192
    ds_read_b64_tr_b16 v[138:139], v4 offset:8704
    ds_read_b64_tr_b16 v[194:195], v5 offset:8704
    ds_read_b64_tr_b16 v[140:141], v4 offset:12288
    ds_read_b64_tr_b16 v[196:197], v5 offset:12288
    s_waitcnt lgkmcnt(13)
    ds_read_b64_tr_b16 v[142:143], v4 offset:12800
    s_waitcnt lgkmcnt(13)
    ds_read_b64_tr_b16 v[198:199], v5 offset:12800
    s_waitcnt lgkmcnt(13)
    ds_read_b64_tr_b16 v[144:145], v4 offset:16384
    s_waitcnt lgkmcnt(13)
    ds_read_b64_tr_b16 v[200:201], v5 offset:16384
    s_waitcnt lgkmcnt(13)
    ds_read_b64_tr_b16 v[146:147], v4 offset:16896
    s_waitcnt lgkmcnt(13)
    ds_read_b64_tr_b16 v[202:203], v5 offset:16896
    s_waitcnt lgkmcnt(13)
    ds_read_b64_tr_b16 v[148:149], v4 offset:20480
    s_waitcnt lgkmcnt(13)
    ds_read_b64_tr_b16 v[204:205], v5 offset:20480
    s_waitcnt lgkmcnt(13)
    ds_read_b64_tr_b16 v[150:151], v4 offset:20992
    s_waitcnt lgkmcnt(13)
    ds_read_b64_tr_b16 v[206:207], v5 offset:20992
    s_waitcnt lgkmcnt(13)
    ds_read_b64_tr_b16 v[152:153], v4 offset:24576
    s_waitcnt lgkmcnt(13)
    ds_read_b64_tr_b16 v[208:209], v5 offset:24576
    s_waitcnt lgkmcnt(13)
    ds_read_b64_tr_b16 v[154:155], v4 offset:25088
    s_waitcnt lgkmcnt(13)
    ds_read_b64_tr_b16 v[210:211], v5 offset:25088
    s_waitcnt lgkmcnt(13)
    ds_read_b64_tr_b16 v[156:157], v4 offset:28672
    s_waitcnt lgkmcnt(13)
    ds_read_b64_tr_b16 v[212:213], v5 offset:28672
    s_waitcnt lgkmcnt(13)
    ds_read_b64_tr_b16 v[158:159], v4 offset:29184
    s_waitcnt lgkmcnt(13)
    ds_read_b64_tr_b16 v[214:215], v5 offset:29184
    s_waitcnt lgkmcnt(13)
    ds_read_b64_tr_b16 v[160:161], v4 offset:32768
    s_waitcnt lgkmcnt(13)
    ds_read_b64_tr_b16 v[216:217], v5 offset:32768
    s_waitcnt lgkmcnt(13)
    ds_read_b64_tr_b16 v[162:163], v4 offset:33280
    s_waitcnt lgkmcnt(13)
    ds_read_b64_tr_b16 v[218:219], v5 offset:33280
    s_waitcnt lgkmcnt(13)
    ds_read_b64_tr_b16 v[164:165], v4 offset:36864
    s_waitcnt lgkmcnt(13)
    ds_read_b64_tr_b16 v[220:221], v5 offset:36864
    s_waitcnt lgkmcnt(13)
    ds_read_b64_tr_b16 v[166:167], v4 offset:37376
    s_waitcnt lgkmcnt(13)
    ds_read_b64_tr_b16 v[222:223], v5 offset:37376
    s_waitcnt lgkmcnt(13)
    ds_read_b64_tr_b16 v[168:169], v4 offset:40960
    s_waitcnt lgkmcnt(13)
    ds_read_b64_tr_b16 v[224:225], v5 offset:40960
    s_waitcnt lgkmcnt(13)
    ds_read_b64_tr_b16 v[170:171], v4 offset:41472
    s_waitcnt lgkmcnt(13)
    ds_read_b64_tr_b16 v[226:227], v5 offset:41472
    s_waitcnt lgkmcnt(13)
    ds_read_b64_tr_b16 v[172:173], v4 offset:45056
    s_waitcnt lgkmcnt(13)
    ds_read_b64_tr_b16 v[228:229], v5 offset:45056
    s_waitcnt lgkmcnt(13)
    ds_read_b64_tr_b16 v[174:175], v4 offset:45568
    s_waitcnt lgkmcnt(13)
    ds_read_b64_tr_b16 v[230:231], v5 offset:45568
    s_waitcnt lgkmcnt(13)
    ds_read_b64_tr_b16 v[176:177], v4 offset:49152
    s_waitcnt lgkmcnt(13)
    ds_read_b64_tr_b16 v[232:233], v5 offset:49152
    s_waitcnt lgkmcnt(13)
    ds_read_b64_tr_b16 v[178:179], v4 offset:49664
    s_waitcnt lgkmcnt(13)
    ds_read_b64_tr_b16 v[234:235], v5 offset:49664
    s_waitcnt lgkmcnt(13)
    ds_read_b64_tr_b16 v[180:181], v4 offset:53248
    s_waitcnt lgkmcnt(13)
    ds_read_b64_tr_b16 v[236:237], v5 offset:53248
    s_waitcnt lgkmcnt(13)
    ds_read_b64_tr_b16 v[182:183], v4 offset:53760
    s_waitcnt lgkmcnt(13)
    ds_read_b64_tr_b16 v[238:239], v5 offset:53760
    s_waitcnt lgkmcnt(13)
    ds_read_b64_tr_b16 v[240:241], v7 offset:0
    s_waitcnt lgkmcnt(13)
    ds_read_b64_tr_b16 v[242:243], v7 offset:3584
    s_waitcnt lgkmcnt(13)
    ds_read_b64_tr_b16 v[244:245], v7 offset:32
    s_waitcnt lgkmcnt(13)
    ds_read_b64_tr_b16 v[246:247], v7 offset:3616
    s_waitcnt lgkmcnt(13)
    ds_read_b64_tr_b16 v[248:249], v7 offset:64
    s_waitcnt lgkmcnt(13)
    ds_read_b64_tr_b16 v[250:251], v7 offset:3648
    s_waitcnt lgkmcnt(13)
    ds_read_b64_tr_b16 v[252:253], v7 offset:96
    s_waitcnt lgkmcnt(13)
    ds_read_b64_tr_b16 v[254:255], v7 offset:3680
    s_waitcnt lgkmcnt(13)
    ds_read_b64_tr_b16 v[28:29], v7 offset:128
    s_waitcnt lgkmcnt(13)
    ds_read_b64_tr_b16 v[30:31], v7 offset:3712
    s_waitcnt lgkmcnt(13)
    ds_read_b64_tr_b16 v[32:33], v7 offset:160
    s_waitcnt lgkmcnt(13)
    ds_read_b64_tr_b16 v[34:35], v7 offset:3744
    s_waitcnt lgkmcnt(13)
    ds_read_b64_tr_b16 v[36:37], v7 offset:192
    s_waitcnt lgkmcnt(13)
    ds_read_b64_tr_b16 v[38:39], v7 offset:3776
    v_lshrrev_b32 v24, 4, v1
    v_bfe_u32 v4, v1, 2, 1
    v_mul_u32_u24 v4, 896, v4
    v_lshl_add_u32 v4, v24, 4, v4
    v_and_b32 v25, 1, v1
    v_lshlrev_b32 v5, 7, v25
    v_lshl_add_u32 v5, v24, 4, v5
    v_lshlrev_b32 v7, 4, v25
    v_lshl_add_u32 v7, v24, 5, v7
    v_and_b32 v3, 1, v24
    v_lshlrev_b32 v3, 7, v3
    v_and_b32 v25, 15, v1
    v_lshl_add_u32 v3, v25, 1, v3
    s_lshl_b32 s25, s3, 5
    v_add_u32 v3, s25, v3
    v_lshrrev_b32 v27, 5, v1
    v_mul_u32_u24 v27, 448, v27
    v_bfe_u32 v26, v1, 3, 2
    s_lshr_b32 s25, s30, 1
    v_add3_u32 v27, v27, v26, s25
    v_lshlrev_b32 v26, 2, v27
    v_lshlrev_b32 v27, 1, v27
    s_waitcnt vmcnt(0)
    v_bfe_u32 v4, v1, 2, 1
    v_mul_u32_u24 v4, 928, v4
    v_lshl_add_u32 v4, v24, 4, v4
    v_and_b32 v25, 3, v1
    v_lshl_add_u32 v4, v25, 6, v4
    s_mov_b32 s24, 0xbdd2d3e8
    v_mov_b32 v72, 0xc0135761
    s_mul_i32 s25, s31, 3584
    s_mul_i32 s26, s3, 896
    s_add_u32 s25, s25, s26
    s_add_u32 s25, s25, 262144
    v_bfe_u32 v25, v1, 1, 3
    v_lshl_add_u32 v7, v25, 7, v7
    s_waitcnt lgkmcnt(0)
    s_barrier
    ds_read_b128 v[40:43], v4 offset:8192
    ds_read_b128 v[44:47], v4 offset:8448
    ds_read_b128 v[48:51], v4 offset:8704
    ds_read_b128 v[52:55], v4 offset:8960
    ds_read_b32 v26, v26 offset:12288
    s_waitcnt lgkmcnt(4)
    v_mfma_f32_16x16x32_bf16 v[8:11], v[40:43], v[128:131], 0
    v_mfma_f32_16x16x32_bf16 v[12:15], v[40:43], v[132:135], 0
    v_mfma_f32_16x16x32_bf16 v[16:19], v[40:43], v[136:139], 0
    v_mfma_f32_16x16x32_bf16 v[20:23], v[40:43], v[140:143], 0
    s_waitcnt lgkmcnt(3)
    v_mfma_f32_16x16x32_bf16 v[8:11], v[44:47], v[144:147], v[8:11]
    v_mfma_f32_16x16x32_bf16 v[12:15], v[44:47], v[148:151], v[12:15]
    v_mfma_f32_16x16x32_bf16 v[16:19], v[44:47], v[152:155], v[16:19]
    v_mfma_f32_16x16x32_bf16 v[20:23], v[44:47], v[156:159], v[20:23]
    s_waitcnt lgkmcnt(2)
    v_mfma_f32_16x16x32_bf16 v[8:11], v[48:51], v[160:163], v[8:11]
    v_mfma_f32_16x16x32_bf16 v[12:15], v[48:51], v[164:167], v[12:15]
    v_mfma_f32_16x16x32_bf16 v[16:19], v[48:51], v[168:171], v[16:19]
    v_mfma_f32_16x16x32_bf16 v[20:23], v[48:51], v[172:175], v[20:23]
    s_waitcnt lgkmcnt(1)
    v_mfma_f32_16x16x32_bf16 v[8:11], v[52:55], v[176:179], v[8:11]
    v_mfma_f32_16x16x32_bf16 v[12:15], v[52:55], v[180:183], v[12:15]
    v_mfma_f32_16x16x32_bf16 v[56:59], v[40:43], v[184:187], 0
    v_mfma_f32_16x16x32_bf16 v[60:63], v[40:43], v[188:191], 0
    v_mfma_f32_16x16x32_bf16 v[64:67], v[40:43], v[192:195], 0
    v_mfma_f32_16x16x32_bf16 v[68:71], v[40:43], v[196:199], 0
    v_mfma_f32_16x16x32_bf16 v[56:59], v[44:47], v[200:203], v[56:59]
    v_add_f32 v18, v18, v23
    v_mfma_f32_16x16x32_bf16 v[60:63], v[44:47], v[204:207], v[60:63]
    v_mfma_f32_16x16x32_bf16 v[64:67], v[44:47], v[208:211], v[64:67]
    v_add_f32 v8, v8, v13
    v_mfma_f32_16x16x32_bf16 v[68:71], v[44:47], v[212:215], v[68:71]
    v_add_f32 v8, v8, v18
    v_mfma_f32_16x16x32_bf16 v[56:59], v[48:51], v[216:219], v[56:59]
    v_mul_f32 v16, v8, v8
    v_mfma_f32_16x16x32_bf16 v[60:63], v[48:51], v[220:223], v[60:63]
    v_fmac_f32 v72, s24, v16
    v_mfma_f32_16x16x32_bf16 v[64:67], v[48:51], v[224:227], v[64:67]
    v_mul_f32 v72, v72, v8
    v_mfma_f32_16x16x32_bf16 v[68:71], v[48:51], v[228:231], v[68:71]
    v_exp_f32 v72, v72
    v_mfma_f32_16x16x32_bf16 v[56:59], v[52:55], v[232:235], v[56:59]
    v_add_f32 v72, 1.0, v72
    v_mfma_f32_16x16x32_bf16 v[60:63], v[52:55], v[236:239], v[60:63]
    v_rcp_f32 v72, v72
    s_nop 0
    v_mul_f32 v16, v8, v72
    s_nop 0
    v_add_f32 v66, v66, v71
    s_nop 0
    v_add_f32 v56, v56, v66
    s_nop 0
    v_add_f32 v56, v56, v61
    v_mul_f32 v16, v16, v56
    v_cvt_pk_bf16_f32 v16, v16, v16
    ds_write_b16 v3, v16 offset:7424
    s_mov_b64 exec, -1
    s_waitcnt lgkmcnt(0)
    s_barrier
    ds_read_b128 v[16:19], v5 offset:7424
    ds_read_b128 v[20:23], v5 offset:7488
    s_waitcnt lgkmcnt(1)
    v_mfma_f32_16x16x32_bf16 v[40:43], v[96:99], v[16:19], 0
    v_mfma_f32_16x16x32_bf16 v[44:47], v[100:103], v[16:19], 0
    v_mfma_f32_16x16x32_bf16 v[48:51], v[104:107], v[16:19], 0
    v_mfma_f32_16x16x32_bf16 v[52:55], v[108:111], v[16:19], 0
    v_mfma_f32_16x16x32_bf16 v[56:59], v[112:115], v[16:19], 0
    v_mfma_f32_16x16x32_bf16 v[60:63], v[116:119], v[16:19], 0
    v_mfma_f32_16x16x32_bf16 v[64:67], v[120:123], v[16:19], 0
    s_waitcnt lgkmcnt(0)
    v_mfma_f32_16x16x32_bf16 v[40:43], v[240:243], v[20:23], v[40:43]
    v_mfma_f32_16x16x32_bf16 v[44:47], v[244:247], v[20:23], v[44:47]
    v_mfma_f32_16x16x32_bf16 v[48:51], v[248:251], v[20:23], v[48:51]
    v_mfma_f32_16x16x32_bf16 v[52:55], v[252:255], v[20:23], v[52:55]
    v_mfma_f32_16x16x32_bf16 v[56:59], v[28:31], v[20:23], v[56:59]
    v_mfma_f32_16x16x32_bf16 v[60:63], v[32:35], v[20:23], v[60:63]
    v_mfma_f32_16x16x32_bf16 v[64:67], v[36:39], v[20:23], v[64:67]
    s_mov_b32 exec_lo, 0x00030003
    s_mov_b32 exec_hi, 0x00030003
    s_lshl_b64 exec, exec, 2
    v_mov_b64 v[40:41], v[44:45]
    v_mov_b64 v[42:43], v[46:47]
    s_lshl_b64 exec, exec, 2
    v_mov_b64 v[40:41], v[48:49]
    v_mov_b64 v[42:43], v[50:51]
    s_lshl_b64 exec, exec, 2
    v_mov_b64 v[40:41], v[52:53]
    v_mov_b64 v[42:43], v[54:55]
    s_lshl_b64 exec, exec, 2
    v_mov_b64 v[40:41], v[56:57]
    v_mov_b64 v[42:43], v[58:59]
    s_lshl_b64 exec, exec, 2
    v_mov_b64 v[40:41], v[60:61]
    v_mov_b64 v[42:43], v[62:63]
    s_lshl_b64 exec, exec, 2
    v_mov_b64 v[40:41], v[64:65]
    v_mov_b64 v[42:43], v[66:67]
    s_mov_b32 exec_lo, 0x3fff3fff
    s_mov_b32 exec_hi, 0x3fff3fff
    s_cmp_eq_u32 s92, 1
    s_cbranch_scc1 L_pza
    buffer_store_dwordx4 v[40:43], v7, s[8:11], s25 offen sc1
    s_branch L_pzb
L_pza:
    buffer_store_dwordx4 v[40:43], v7, s[8:11], s25 offen
L_pzb:
    s_mov_b64 exec, -1
    s_mov_b32 s12, s50
    s_mov_b32 s13, s51
    s_cmp_eq_u32 s89, 0
    s_cselect_b32 s14, 1792, 0
    s_mov_b32 s61, 200000
L_zpoll:
    buffer_load_dwordx4 v[12:15], v0, s[8:11], s27 offen sc1
    s_sub_u32 s61, s61, 1
    s_cmp_eq_u32 s61, 0
    s_cbranch_scc1 L_zto
    s_waitcnt vmcnt(0)
    v_max3_u32 v8, v12, v13, v14
    v_max_u32 v8, v8, v15
    v_cmp_eq_u32 vcc, -1, v8
    s_mov_b64 exec, vcc
    s_cbranch_execnz L_zpoll
L_zto:
    s_mov_b64 exec, -1
    s_waitcnt vmcnt(0)
    v_permlane16_swap_b32 v12, v14
    v_permlane16_swap_b32 v13, v15
    v_add_f32 v12, v12, v14
    v_add_f32 v13, v13, v15
    s_nop 0
    v_add_f32_dpp v12, v12, v12 row_ror:8 row_mask:0xf bank_mask:0x3
    s_nop 1
    v_add_f32_dpp v12, v13, v13 row_ror:8 row_mask:0xf bank_mask:0xc
    s_nop 1
    v_add_f32_dpp v12, v12, v12 row_half_mirror row_mask:0xf bank_mask:0xf
    s_nop 1
    v_add_f32_dpp v12, v12, v12 quad_perm:[1,0,3,2] row_mask:0xf bank_mask:0xf
    s_nop 1
    v_add_f32_dpp v12, v12, v12 quad_perm:[2,3,0,1] row_mask:0xf bank_mask:0xf
    v_add_f32 v12, v12, v26
    v_cvt_pk_bf16_f32 v12, v12, v12
    s_mov_b32 exec_lo, 0x01010101
    s_mov_b32 exec_hi, 0x01010101
    buffer_store_short v12, v27, s[12:15], 0 offen
    s_mov_b64 exec, -1
    s_branch L_exit
L_nonce:
    s_lshl_b32 s30, s31, 1
    s_add_u32 s30, s30, s3
    s_sub_u32 s30, s30, 4
    s_cmp_lg_u32 s30, 0
    s_cbranch_scc1 L_exit
    s_add_u32 s24, s56, 1
    v_mov_b32 v8, s24
    v_mov_b32 v9, 0
    s_mov_b64 exec, 1
    buffer_store_dword v8, v9, s[8:11], 0 offen sc1
    s_mov_b64 exec, -1
    s_branch L_exit
L_service:
    s_mul_i32 s24, s58, 917504
    s_mul_i32 s25, s3, 229376
    s_add_u32 s24, s24, s25
    s_lshl_b32 s25, s59, 7
    s_add_u32 s24, s24, s25
    s_add_u32 s16, s40, s24
    s_addc_u32 s17, s41, 0
    s_sub_u32 s18, 3670016, s24
    v_lshrrev_b32 v4, 3, v1
    v_mul_u32_u24 v4, 896, v4
    v_and_b32 v5, 7, v1
    v_bfe_u32 v6, v1, 4, 1
    v_lshl_or_b32 v6, v6, 1, 0
    v_xor_b32 v5, v5, v6
    v_lshl_add_u32 v4, v5, 4, v4
    s_lshl_b32 s26, s3, 15
    s_add_u32 s26, s26, 16384
    s_mov_b32 m0, s26
    s_mov_b32 s24, 0
    s_mov_b32 s25, 32
L_w1:
    buffer_load_dwordx4 v4, s[16:19], s24 offen nt lds
    s_add_u32 m0, m0, 1024
    s_addk_i32 s24, 7168
    v_xor_b32 v4, 64, v4
    s_sub_u32 s25, s25, 1
    s_cmp_lg_u32 s25, 0
    s_cbranch_scc1 L_w1
    v_lshrrev_b32 v18, 4, v1
    v_lshlrev_b32 v18, 3, v18
    v_bfe_u32 v30, v1, 2, 2
    v_add_u32 v18, v18, v30
    v_lshlrev_b32 v18, 7, v18
    v_and_b32 v30, 3, v1
    v_lshl_add_u32 v18, v30, 3, v18
    v_add_u32 v18, s26, v18
    v_bfe_u32 v19, v1, 3, 2
    v_xor_b32 v12, 0, v19
    v_lshl_add_u32 v12, v12, 5, v18
    v_xor_b32 v13, 1, v19
    v_lshl_add_u32 v13, v13, 5, v18
    v_xor_b32 v14, 2, v19
    v_lshl_add_u32 v14, v14, 5, v18
    v_xor_b32 v15, 3, v19
    v_lshl_add_u32 v15, v15, 5, v18
    s_waitcnt vmcnt(28) lgkmcnt(0)
    ds_read_b64_tr_b16 v[128:129], v12 offset:0
    ds_read_b64_tr_b16 v[130:131], v12 offset:512
    ds_read_b64_tr_b16 v[132:133], v13 offset:0
    ds_read_b64_tr_b16 v[134:135], v13 offset:512
    ds_read_b64_tr_b16 v[136:137], v14 offset:0
    ds_read_b64_tr_b16 v[138:139], v14 offset:512
    ds_read_b64_tr_b16 v[140:141], v15 offset:0
    ds_read_b64_tr_b16 v[142:143], v15 offset:512
    s_waitcnt vmcnt(24) lgkmcnt(0)
    ds_read_b64_tr_b16 v[144:145], v12 offset:4096
    ds_read_b64_tr_b16 v[146:147], v12 offset:4608
    ds_read_b64_tr_b16 v[148:149], v13 offset:4096
    ds_read_b64_tr_b16 v[150:151], v13 offset:4608
    ds_read_b64_tr_b16 v[152:153], v14 offset:4096
    ds_read_b64_tr_b16 v[154:155], v14 offset:4608
    ds_read_b64_tr_b16 v[156:157], v15 offset:4096
    ds_read_b64_tr_b16 v[158:159], v15 offset:4608
    s_waitcnt vmcnt(20) lgkmcnt(0)
    ds_read_b64_tr_b16 v[160:161], v12 offset:8192
    ds_read_b64_tr_b16 v[162:163], v12 offset:8704
    ds_read_b64_tr_b16 v[164:165], v13 offset:8192
    ds_read_b64_tr_b16 v[166:167], v13 offset:8704
    ds_read_b64_tr_b16 v[168:169], v14 offset:8192
    ds_read_b64_tr_b16 v[170:171], v14 offset:8704
    ds_read_b64_tr_b16 v[172:173], v15 offset:8192
    ds_read_b64_tr_b16 v[174:175], v15 offset:8704
    s_waitcnt vmcnt(16) lgkmcnt(0)
    ds_read_b64_tr_b16 v[176:177], v12 offset:12288
    ds_read_b64_tr_b16 v[178:179], v12 offset:12800
    ds_read_b64_tr_b16 v[180:181], v13 offset:12288
    ds_read_b64_tr_b16 v[182:183], v13 offset:12800
    ds_read_b64_tr_b16 v[184:185], v14 offset:12288
    ds_read_b64_tr_b16 v[186:187], v14 offset:12800
    ds_read_b64_tr_b16 v[188:189], v15 offset:12288
    ds_read_b64_tr_b16 v[190:191], v15 offset:12800
    s_waitcnt vmcnt(12) lgkmcnt(0)
    ds_read_b64_tr_b16 v[192:193], v12 offset:16384
    ds_read_b64_tr_b16 v[194:195], v12 offset:16896
    ds_read_b64_tr_b16 v[196:197], v13 offset:16384
    ds_read_b64_tr_b16 v[198:199], v13 offset:16896
    ds_read_b64_tr_b16 v[200:201], v14 offset:16384
    ds_read_b64_tr_b16 v[202:203], v14 offset:16896
    ds_read_b64_tr_b16 v[204:205], v15 offset:16384
    ds_read_b64_tr_b16 v[206:207], v15 offset:16896
    s_waitcnt vmcnt(8) lgkmcnt(0)
    ds_read_b64_tr_b16 v[208:209], v12 offset:20480
    ds_read_b64_tr_b16 v[210:211], v12 offset:20992
    ds_read_b64_tr_b16 v[212:213], v13 offset:20480
    ds_read_b64_tr_b16 v[214:215], v13 offset:20992
    ds_read_b64_tr_b16 v[216:217], v14 offset:20480
    ds_read_b64_tr_b16 v[218:219], v14 offset:20992
    ds_read_b64_tr_b16 v[220:221], v15 offset:20480
    ds_read_b64_tr_b16 v[222:223], v15 offset:20992
    s_waitcnt vmcnt(4) lgkmcnt(0)
    ds_read_b64_tr_b16 v[224:225], v12 offset:24576
    ds_read_b64_tr_b16 v[226:227], v12 offset:25088
    ds_read_b64_tr_b16 v[228:229], v13 offset:24576
    ds_read_b64_tr_b16 v[230:231], v13 offset:25088
    ds_read_b64_tr_b16 v[232:233], v14 offset:24576
    ds_read_b64_tr_b16 v[234:235], v14 offset:25088
    ds_read_b64_tr_b16 v[236:237], v15 offset:24576
    ds_read_b64_tr_b16 v[238:239], v15 offset:25088
    s_waitcnt vmcnt(0) lgkmcnt(0)
    ds_read_b64_tr_b16 v[240:241], v12 offset:28672
    ds_read_b64_tr_b16 v[242:243], v12 offset:29184
    ds_read_b64_tr_b16 v[244:245], v13 offset:28672
    ds_read_b64_tr_b16 v[246:247], v13 offset:29184
    ds_read_b64_tr_b16 v[248:249], v14 offset:28672
    ds_read_b64_tr_b16 v[250:251], v14 offset:29184
    ds_read_b64_tr_b16 v[252:253], v15 offset:28672
    ds_read_b64_tr_b16 v[254:255], v15 offset:29184
    s_and_b32 s24, s3, 1
    s_lshl_b32 s24, s24, 2
    v_lshrrev_b32 v4, 3, v1
    v_mul_u32_u24 v4, 3584, v4
    v_and_b32 v5, 7, v1
    v_bfe_u32 v6, v1, 4, 1
    v_lshl_or_b32 v6, v6, 1, s24
    v_xor_b32 v5, v5, v6
    v_lshl_add_u32 v4, v5, 4, v4
    s_waitcnt lgkmcnt(0)
    s_barrier
    s_mul_i32 s24, s31, 57344
    s_add_u32 s24, s24, 0
    s_add_u32 s16, s48, s24
    s_addc_u32 s17, s49, 0
    s_mov_b32 s18, 28672
    s_add_u32 m0, s23, 131072
    s_mov_b32 s24, 0
    buffer_load_dwordx4 v2, s[16:19], s24 offen nt lds
    s_add_u32 m0, m0, 4096
    s_addk_i32 s24, 0x1000
    buffer_load_dwordx4 v2, s[16:19], s24 offen nt lds
    s_add_u32 m0, m0, 4096
    s_addk_i32 s24, 0x1000
    buffer_load_dwordx4 v2, s[16:19], s24 offen nt lds
    s_add_u32 m0, m0, 4096
    s_addk_i32 s24, 0x1000
    buffer_load_dwordx4 v2, s[16:19], s24 offen nt lds
    s_add_u32 m0, m0, 4096
    s_addk_i32 s24, 0x1000
    buffer_load_dwordx4 v2, s[16:19], s24 offen nt lds
    s_add_u32 m0, m0, 4096
    s_addk_i32 s24, 0x1000
    buffer_load_dwordx4 v2, s[16:19], s24 offen nt lds
    s_add_u32 m0, m0, 4096
    s_addk_i32 s24, 0x1000
    buffer_load_dwordx4 v2, s[16:19], s24 offen nt lds
    s_add_u32 m0, m0, 4096
    s_addk_i32 s24, 0x1000
    s_lshl_b32 s24, s31, 7
    s_add_u32 s16, s44, s24
    s_addc_u32 s17, s45, 0
    s_sub_u32 s18, 1605632, s24
    s_mul_i32 s24, s3, 28672
    s_add_u32 m0, s23, 16384
    s_mov_b32 s25, 14
L_w2:
    buffer_load_dwordx4 v4, s[16:19], s24 offen nt lds
    s_add_u32 m0, m0, 4096
    s_add_u32 s24, s24, 114688
    s_sub_u32 s25, s25, 1
    s_cmp_lg_u32 s25, 0
    s_cbranch_scc1 L_w2
    s_lshl_b32 s24, s31, 7
    s_add_u32 s16, s46, s24
    s_addc_u32 s17, s47, 0
    s_sub_u32 s18, 1605632, s24
    s_mul_i32 s24, s3, 28672
    s_add_u32 m0, s23, 73728
    s_mov_b32 s25, 14
L_w3:
    buffer_load_dwordx4 v4, s[16:19], s24 offen nt lds
    s_add_u32 m0, m0, 4096
    s_add_u32 s24, s24, 114688
    s_sub_u32 s25, s25, 1
    s_cmp_lg_u32 s25, 0
    s_cbranch_scc1 L_w3
    v_lshrrev_b32 v7, 4, v1
    v_lshlrev_b32 v7, 3, v7
    v_bfe_u32 v30, v1, 2, 2
    v_add_u32 v7, v7, v30
    v_mul_u32_u24 v7, 896, v7
    v_and_b32 v30, 3, v1
    v_lshl_add_u32 v7, v30, 3, v7
    s_mul_i32 s25, s3, 224
    s_add_u32 s25, s25, 131072
    v_add_u32 v7, s25, v7
    s_waitcnt vmcnt(28)
    s_barrier
    ds_read_b64_tr_b16 v[96:97], v7 offset:0
    ds_read_b64_tr_b16 v[98:99], v7 offset:3584
    ds_read_b64_tr_b16 v[100:101], v7 offset:32
    ds_read_b64_tr_b16 v[102:103], v7 offset:3616
    ds_read_b64_tr_b16 v[104:105], v7 offset:64
    ds_read_b64_tr_b16 v[106:107], v7 offset:3648
    ds_read_b64_tr_b16 v[108:109], v7 offset:96
    ds_read_b64_tr_b16 v[110:111], v7 offset:3680
    ds_read_b64_tr_b16 v[112:113], v7 offset:128
    ds_read_b64_tr_b16 v[114:115], v7 offset:3712
    ds_read_b64_tr_b16 v[116:117], v7 offset:160
    ds_read_b64_tr_b16 v[118:119], v7 offset:3744
    ds_read_b64_tr_b16 v[120:121], v7 offset:192
    ds_read_b64_tr_b16 v[122:123], v7 offset:3776
    s_waitcnt lgkmcnt(0)
    s_barrier
    s_mul_i32 s24, s31, 57344
    s_add_u32 s24, s24, 28672
    s_add_u32 s16, s48, s24
    s_addc_u32 s17, s49, 0
    s_mov_b32 s18, 28672
    s_add_u32 m0, s23, 131072
    s_mov_b32 s24, 0
    buffer_load_dwordx4 v2, s[16:19], s24 offen nt lds
    s_add_u32 m0, m0, 4096
    s_addk_i32 s24, 0x1000
    buffer_load_dwordx4 v2, s[16:19], s24 offen nt lds
    s_add_u32 m0, m0, 4096
    s_addk_i32 s24, 0x1000
    buffer_load_dwordx4 v2, s[16:19], s24 offen nt lds
    s_add_u32 m0, m0, 4096
    s_addk_i32 s24, 0x1000
    buffer_load_dwordx4 v2, s[16:19], s24 offen nt lds
    s_add_u32 m0, m0, 4096
    s_addk_i32 s24, 0x1000
    buffer_load_dwordx4 v2, s[16:19], s24 offen nt lds
    s_add_u32 m0, m0, 4096
    s_addk_i32 s24, 0x1000
    buffer_load_dwordx4 v2, s[16:19], s24 offen nt lds
    s_add_u32 m0, m0, 4096
    s_addk_i32 s24, 0x1000
    buffer_load_dwordx4 v2, s[16:19], s24 offen nt lds
    s_add_u32 m0, m0, 4096
    s_addk_i32 s24, 0x1000
    buffer_load_dwordx4 v[64:67], v2, s[4:7], s22 offen nt
    s_addk_i32 s22, 0x1000
    buffer_load_dwordx4 v[68:71], v2, s[4:7], s22 offen nt
    s_addk_i32 s22, 0x1000
    buffer_load_dwordx4 v[72:75], v2, s[4:7], s22 offen nt
    s_addk_i32 s22, 0x1000
    buffer_load_dwordx4 v[76:79], v2, s[4:7], s22 offen nt
    s_addk_i32 s22, 0x1000
    buffer_load_dwordx4 v[80:83], v2, s[4:7], s22 offen nt
    s_addk_i32 s22, 0x1000
    buffer_load_dwordx4 v[84:87], v2, s[4:7], s22 offen nt
    s_addk_i32 s22, 0x1000
    buffer_load_dwordx4 v[88:91], v2, s[4:7], s22 offen nt
    s_addk_i32 s22, 0x1000
    buffer_load_dwordx4 v[92:95], v2, s[4:7], s22 offen nt
    s_addk_i32 s22, 0x1000
    s_mul_i32 s25, s3, 1280
    v_lshl_add_u32 v61, v1, 4, s25
    v_lshl_add_u32 v60, v1, 2, s25
    v_mov_b32 v16, 0xff800000
    v_mov_b32 v17, 0xff800000
    v_mov_b32 v18, 0xff800000
    v_mov_b32 v19, 0xff800000
    ds_write_b128 v61, v[16:19] offset:0
    ds_write_b32 v60, v16 offset:1024
    v_lshrrev_b32 v3, 5, v1
    v_mul_u32_u24 v3, 640, v3
    v_add_u32 v3, s25, v3
    v_mov_b32 v62, v3
    v_bfe_u32 v20, v1, 2, 3
    v_lshl_add_u32 v3, v20, 2, v3
    v_and_b32 v20, 31, v1
    v_lshlrev_b32 v20, 4, v20
    s_add_u32 s20, s36, s85
    s_addc_u32 s21, s37, 0
    s_barrier
    ds_read_b128 v[4:7], v20 offset:5120
    s_mov_b32 s24, s84
    s_waitcnt lgkmcnt(0)
    s_branch L_kloop
L_helper6:
    v_lshlrev_b32 v2, 4, v1
    v_mov_b32 v29, 0
    s_cmp_lg_u32 s57, 1
    s_cbranch_scc1 L_h6a
    s_barrier
    s_barrier
    s_barrier
L_h6a:
    s_cmp_lg_u32 s57, 1
    s_cbranch_scc1 L_exit
    s_mov_b32 s12, s32
    s_mov_b32 s13, s33
    s_mov_b32 s14, 1792
    s_and_b32 s24, s3, 1
    s_mul_i32 s24, s24, 896
    v_mov_b32 v20, 0x10000
    v_cmp_gt_u32 vcc, 56, v1
    v_lshlrev_b32 v21, 3, v1
    s_nop 0
    v_cndmask_b32 v20, v20, v21, vcc
    buffer_load_dwordx2 v[124:125], v20, s[12:15], s24 offen
    buffer_load_dwordx2 v[126:127], v20, s[12:15], s24 offen offset:448
    s_barrier
L_ln:
    v_lshlrev_b32 v6, 4, v1
    v_mov_b32 v20, 0x7fff0000
    v_cmp_gt_u32 vcc, 56, v1
    s_nop 1
    v_cndmask_b32 v6, v20, v6, vcc
    s_and_b32 s26, s3, 1
    s_mul_i32 s26, s26, 1792
    s_add_u32 s26, s26, 229376
    s_barrier
    s_mov_b32 s25, s26
    buffer_load_dwordx4 v[64:67], v6, s[8:11], s25 offen offset:0 sc1
    buffer_load_dwordx4 v[68:71], v6, s[8:11], s25 offen offset:896 sc1
    s_addk_i32 s25, 3584
    buffer_load_dwordx4 v[72:75], v6, s[8:11], s25 offen offset:0 sc1
    buffer_load_dwordx4 v[76:79], v6, s[8:11], s25 offen offset:896 sc1
    s_addk_i32 s25, 3584
    buffer_load_dwordx4 v[80:83], v6, s[8:11], s25 offen offset:0 sc1
    buffer_load_dwordx4 v[84:87], v6, s[8:11], s25 offen offset:896 sc1
    s_addk_i32 s25, 3584
    buffer_load_dwordx4 v[88:91], v6, s[8:11], s25 offen offset:0 sc1
    buffer_load_dwordx4 v[92:95], v6, s[8:11], s25 offen offset:896 sc1
    s_waitcnt vmcnt(8)
    v_lshlrev_b32 v16, 16, v124
    v_and_b32 v17, 0xffff0000, v124
    v_lshlrev_b32 v18, 16, v125
    v_and_b32 v19, 0xffff0000, v125
    v_lshlrev_b32 v20, 16, v126
    v_and_b32 v21, 0xffff0000, v126
    v_lshlrev_b32 v22, 16, v127
    v_and_b32 v23, 0xffff0000, v127
    s_mov_b32 s61, 200000
    s_mov_b32 s29, 0x3b124925
    s_and_b32 s24, s3, 1
    s_mul_i32 s24, s24, 1792
    v_lshl_add_u32 v40, v1, 4, s24
    s_and_b32 s24, s3, 1
    s_mul_i32 s24, s24, 928
    s_add_u32 s24, s24, 2560
    v_lshl_add_u32 v41, v1, 3, s24
    s_and_b32 s24, s3, 1
    s_lshl_b32 s24, s24, 3
    v_mov_b32 v42, s24
    s_barrier
L_ypoll:
    s_mov_b32 s25, s26
    buffer_load_dwordx4 v[64:67], v6, s[8:11], s25 offen offset:0 sc1
    buffer_load_dwordx4 v[68:71], v6, s[8:11], s25 offen offset:896 sc1
    s_addk_i32 s25, 3584
    buffer_load_dwordx4 v[72:75], v6, s[8:11], s25 offen offset:0 sc1
    buffer_load_dwordx4 v[76:79], v6, s[8:11], s25 offen offset:896 sc1
    s_addk_i32 s25, 3584
    buffer_load_dwordx4 v[80:83], v6, s[8:11], s25 offen offset:0 sc1
    buffer_load_dwordx4 v[84:87], v6, s[8:11], s25 offen offset:896 sc1
    s_addk_i32 s25, 3584
    buffer_load_dwordx4 v[88:91], v6, s[8:11], s25 offen offset:0 sc1
    buffer_load_dwordx4 v[92:95], v6, s[8:11], s25 offen offset:896 sc1
    s_sub_u32 s61, s61, 1
    s_waitcnt vmcnt(4)
    v_pk_add_f32 v[64:65], v[64:65], v[72:73]
    v_pk_add_f32 v[66:67], v[66:67], v[74:75]
    v_pk_add_f32 v[68:69], v[68:69], v[76:77]
    v_pk_add_f32 v[70:71], v[70:71], v[78:79]
    v_pk_add_f32 v[8:9], v[16:17], v[64:65]
    v_pk_add_f32 v[10:11], v[18:19], v[66:67]
    v_pk_add_f32 v[12:13], v[20:21], v[68:69]
    v_pk_add_f32 v[14:15], v[22:23], v[70:71]
    s_waitcnt vmcnt(0)
    v_pk_add_f32 v[80:81], v[80:81], v[88:89]
    v_pk_add_f32 v[82:83], v[82:83], v[90:91]
    v_pk_add_f32 v[84:85], v[84:85], v[92:93]
    v_pk_add_f32 v[86:87], v[86:87], v[94:95]
    v_pk_add_f32 v[8:9], v[8:9], v[80:81]
    v_pk_add_f32 v[10:11], v[10:11], v[82:83]
    v_pk_add_f32 v[12:13], v[12:13], v[84:85]
    v_pk_add_f32 v[14:15], v[14:15], v[86:87]
    v_pk_add_f32 v[24:25], v[8:9], v[10:11]
    v_pk_add_f32 v[26:27], v[12:13], v[14:15]
    v_pk_add_f32 v[24:25], v[24:25], v[26:27]
    v_add_f32 v24, v24, v25
    s_cmp_eq_u32 s61, 0
    s_cbranch_scc1 L_yto
    v_cmp_u_f32 vcc, v24, v24
    s_mov_b64 exec, vcc
    s_cbranch_execnz L_ypoll
L_yto:
    s_mov_b64 exec, -1
    v_pk_mul_f32 v[26:27], v[8:9], v[8:9]
    v_pk_fma_f32 v[26:27], v[10:11], v[10:11], v[26:27]
    v_pk_fma_f32 v[26:27], v[12:13], v[12:13], v[26:27]
    v_pk_fma_f32 v[26:27], v[14:15], v[14:15], v[26:27]
    v_add_f32 v26, v26, v27
    s_mov_b32 exec_hi, 0x00ffffff
    ds_write_b128 v40, v[8:11] offset:12288
    ds_write_b128 v40, v[12:15] offset:13184
    s_mov_b64 exec, -1
    v_add_f32_dpp v24, v24, v24 quad_perm:[1,0,3,2] row_mask:0xf bank_mask:0xf
    v_add_f32_dpp v26, v26, v26 quad_perm:[1,0,3,2] row_mask:0xf bank_mask:0xf
    s_nop 0
    v_add_f32_dpp v24, v24, v24 quad_perm:[2,3,0,1] row_mask:0xf bank_mask:0xf
    v_add_f32_dpp v26, v26, v26 quad_perm:[2,3,0,1] row_mask:0xf bank_mask:0xf
    s_nop 0
    v_add_f32_dpp v24, v24, v24 row_half_mirror row_mask:0xf bank_mask:0xf
    v_add_f32_dpp v26, v26, v26 row_half_mirror row_mask:0xf bank_mask:0xf
    s_nop 0
    v_add_f32_dpp v24, v24, v24 row_mirror row_mask:0xf bank_mask:0xf
    v_add_f32_dpp v26, v26, v26 row_mirror row_mask:0xf bank_mask:0xf
    v_mov_b32 v25, v24
    v_mov_b32 v27, v26
    s_nop 0
    v_permlane16_swap_b32 v24, v25
    v_permlane16_swap_b32 v26, v27
    v_add_f32 v24, v24, v25
    v_add_f32 v26, v26, v27
    v_mov_b32 v25, v24
    v_mov_b32 v27, v26
    s_nop 0
    v_permlane32_swap_b32 v24, v25
    v_permlane32_swap_b32 v26, v27
    v_add_f32 v24, v24, v25
    v_add_f32 v26, v26, v27
    v_mul_f32 v24, s29, v24
    v_mov_b32 v25, 0x3727c5ac
    v_fmac_f32 v25, s29, v26
    v_fma_f32 v25, -v24, v24, v25
    v_rsq_f32 v25, v25
    v_sub_f32 v16, v8, v24
    v_sub_f32 v17, v9, v24
    v_sub_f32 v18, v10, v24
    v_sub_f32 v19, v11, v24
    v_sub_f32 v20, v12, v24
    v_sub_f32 v21, v13, v24
    v_sub_f32 v22, v14, v24
    v_sub_f32 v23, v15, v24
    v_mul_f32 v16, v16, v25
    v_mul_f32 v17, v17, v25
    v_mul_f32 v18, v18, v25
    v_mul_f32 v19, v19, v25
    v_mul_f32 v20, v20, v25
    v_mul_f32 v21, v21, v25
    v_mul_f32 v22, v22, v25
    v_mul_f32 v23, v23, v25
    v_cvt_pk_bf16_f32 v16, v16, v17
    v_cvt_pk_bf16_f32 v17, v18, v19
    v_cvt_pk_bf16_f32 v18, v20, v21
    v_cvt_pk_bf16_f32 v19, v22, v23
    s_mov_b32 exec_hi, 0x00ffffff
    ds_write_b64 v41, v[16:17] offset:5632
    ds_write_b64 v41, v[18:19] offset:6080
    s_mov_b64 exec, -1
    s_waitcnt lgkmcnt(0)
    s_barrier
    s_branch L_nonce
L_helper:
    s_cmp_eq_u32 s3, 5
    s_cbranch_scc1 L_helper6
    v_lshlrev_b32 v2, 4, v1
    v_lshlrev_b32 v3, 2, v1
    v_mov_b32 v29, 0
    ds_write_b32 v3, v29 offset:7936
    ds_write_b32 v29, v29 offset:7744
    ds_write_b32 v29, v29 offset:7752
    ds_write_b32 v29, v29 offset:7756
    s_waitcnt lgkmcnt(0)
    s_xor_b32 s60, s56, 0x9e3779b9
    s_cmp_eq_u32 s57, 0
    s_cbranch_scc1 L_h1
    s_cmp_eq_u32 s57, 3
    s_cbranch_scc1 L_h0
    v_mov_b32 v16, -1
    v_mov_b32 v17, -1
    v_mov_b32 v18, -1
    v_mov_b32 v19, -1
    s_mul_i32 s24, s31, 3584
    s_add_u32 s24, s24, 262144
    s_lshl_b32 s25, s31, 9
    s_add_u32 s25, s25, 229376
    buffer_store_dwordx4 v[16:19], v2, s[8:11], s24 offen offset:0 sc1
    buffer_store_dwordx4 v[16:19], v2, s[8:11], s24 offen offset:1024 sc1
    buffer_store_dwordx4 v[16:19], v2, s[8:11], s24 offen offset:2048 sc1
    s_mov_b32 exec_hi, 0
    buffer_store_dwordx4 v[16:19], v2, s[8:11], s24 offen offset:3072 sc1
    buffer_store_dwordx4 v[16:19], v2, s[8:11], s25 offen sc1
    s_mov_b64 exec, -1
    s_getreg_b32 s92, hwreg(HW_REG_XCC_ID)
    s_and_b32 s92, s92, 15
    v_mov_b32 v8, s92
    v_mov_b32 v9, s60
    s_lshl_b32 s24, s31, 7
    s_add_u32 s24, s24, 40960
    s_waitcnt vmcnt(0)
    s_mov_b64 exec, 1
    buffer_store_dwordx2 v[8:9], v29, s[8:11], s24 offen sc1
    s_mov_b64 exec, -1
    s_barrier
L_h0:
    s_barrier
L_h1:
    s_barrier
    s_lshl_b32 s24, s31, 10
    s_add_u32 s24, s24, 4096
    s_mov_b32 s61, 200000
L_qpoll:
    buffer_load_dwordx4 v[8:11], v2, s[8:11], s24 offen sc1
    s_sub_u32 s61, s61, 1
    s_cmp_eq_u32 s61, 0
    s_cbranch_scc1 L_qto
    s_waitcnt vmcnt(0)
    v_cmp_ne_u32 vcc, s60, v9
    v_cmp_ne_u32 s[26:27], s60, v11
    s_or_b64 vcc, vcc, s[26:27]
    s_cbranch_vccnz L_qpoll
L_qto:
    s_waitcnt vmcnt(0)
    v_mov_b32 v9, v10
    v_lshlrev_b32 v3, 3, v1
    ds_write_b64 v3, v[8:9] offset:5120
    s_waitcnt lgkmcnt(0)
    s_barrier
    s_cmp_lg_u32 s57, 1
    s_cbranch_scc1 L_h2
    s_mov_b32 s12, s32
    s_mov_b32 s13, s33
    s_mov_b32 s14, 1792
    s_and_b32 s24, s3, 1
    s_mul_i32 s24, s24, 896
    v_mov_b32 v20, 0x10000
    v_cmp_gt_u32 vcc, 56, v1
    v_lshlrev_b32 v21, 3, v1
    s_nop 0
    v_cndmask_b32 v20, v20, v21, vcc
    buffer_load_dwordx2 v[124:125], v20, s[12:15], s24 offen
    buffer_load_dwordx2 v[126:127], v20, s[12:15], s24 offen offset:448
    s_mov_b32 s61, 200000
    v_lshlrev_b32 v4, 8, v1
    v_min_u32 v5, 27, v1
    v_lshlrev_b32 v5, 7, v5
    s_mov_b32 s24, 4096
    s_mov_b32 s25, 40960
L_hchk:
    buffer_load_dwordx2 v[8:9], v4, s[8:11], s24 offen sc1
    buffer_load_dwordx2 v[10:11], v5, s[8:11], s25 offen sc1
    s_sub_u32 s61, s61, 1
    s_cmp_eq_u32 s61, 0
    s_waitcnt vmcnt(0)
    s_cbranch_scc1 L_hto
    v_cmp_ne_u32 vcc, s60, v9
    v_cmp_ne_u32 s[26:27], s60, v11
    s_or_b64 vcc, vcc, s[26:27]
    s_cbranch_vccnz L_hchk
L_hto:
    v_cmp_ne_u32 vcc, s92, v10
    s_cmp_eq_u64 vcc, 0
    s_cselect_b32 s24, 1, 0
    v_mov_b32 v8, s24
    ds_write_b32 v29, v8 offset:7748
L_h2:
    s_mul_i32 s24, s31, 4352
    s_add_u32 s24, s24, 393216
    s_mov_b32 s20, s24
    s_cmp_eq_u32 s57, 1
    s_cselect_b32 s21, 6, 32
    v_mov_b32 v22, 7936
    s_mov_b32 s94, 1
L_cwait:
    ds_read_b32 v23, v29 offset:7744
    s_waitcnt lgkmcnt(0)
    v_readfirstlane_b32 s24, v23
    s_cmp_lt_u32 s24, s94
    s_cbranch_scc1 L_cwait
    v_mov_b32 v24, 1
    s_mov_b64 exec, 1
    buffer_atomic_add v24, v29, s[8:11], s20 offen sc0 sc1
    s_mov_b64 exec, -1
    s_add_u32 s94, s94, 1
    s_waitcnt vmcnt(0)
    v_readfirstlane_b32 s24, v24
    s_min_u32 s24, s24, 32
    s_add_u32 s25, s24, 1
    v_mov_b32 v23, s25
    ds_write_b32 v22, v23
    v_add_u32 v22, 4, v22
    s_cmp_lt_u32 s24, s21
    s_cbranch_scc1 L_cwait
L_cdone:
    v_mov_b32 v23, 33
    ds_write_b32 v22, v23
    s_cmp_eq_u32 s57, 1
    s_cbranch_scc1 L_ln
L_exit:
L_end:
    s_endpgm
.section .rodata,"a"
.p2align 6
.amdhsa_kernel sequential_preLN__mha_block_cached__geglu_ffn__decode_kernel
.amdhsa_next_free_vgpr 256
.amdhsa_next_free_sgpr 96
.amdhsa_accum_offset 256
.amdhsa_group_segment_fixed_size 0
.amdhsa_kernarg_size 96
.amdhsa_user_sgpr_count 2
.amdhsa_user_sgpr_kernarg_segment_ptr 1
.amdhsa_system_sgpr_workgroup_id_x 1
.end_amdhsa_kernel
```
